```python
import torch

def _softmax(x, axis=-1):
    return torch.softmax(x, dim=axis)
def _gelu(x):
    return torch.nn.functional.gelu(x, approximate="tanh")
def _silu(x):
    return torch.nn.functional.silu(x)
def _sigmoid(x):
    return torch.sigmoid(x)
def _layernorm(x, axis=-1, eps=1e-5):
    m = x.mean(dim=axis, keepdim=True)
    v = x.var(dim=axis, keepdim=True, unbiased=False)
    return (x - m) / torch.sqrt(v + eps)
def _scatter_add(tgt, idx, src, axis=0):
    return tgt.clone().index_add_(axis, idx, src)
def _segment_sum(src, seg, n):
    out = torch.zeros((n,) + src.shape[1:], dtype=src.dtype)
    return out.index_add_(0, seg, src)
def _pad(x, pw):
    flat = tuple(v for pair in reversed(pw) for v in pair)
    return torch.nn.functional.pad(x, flat)

kernel_name = 'sequential_preLN__mha_block__mixer_channel_mlp__prompt'

def setup_inputs():

    _w = (lambda a: (lambda t: t.to(torch.bfloat16) if t.is_floating_point() else t)(torch.as_tensor(a)))
    def _A_setup():
        B, S, D, H = 1, 2048, 1024, 32
        return {
            "x": _w((lambda *s: torch.randn(*s, dtype=torch.bfloat16) * 0.05)(B, S, D)),
            "wqkv": _w((lambda *s: torch.randn(*s, dtype=torch.bfloat16) * 0.05)(D, 3 * D)),
            "wo": _w((lambda *s: torch.randn(*s, dtype=torch.bfloat16) * 0.05)(D, D)),
        }
    _A_in = _A_setup()

    def _B_setup():
        B, S, D, F = 1, 2048, 1024, 3584
        return {
            "x": _w((lambda *s: torch.randn(*s, dtype=torch.bfloat16) * 0.05)(B, S, D)),
            "w1": _w((lambda *s: torch.randn(*s, dtype=torch.bfloat16) * 3.2)(D, F) * (D ** -0.5)),
            "b1": _w((lambda *s: torch.randn(*s, dtype=torch.bfloat16) * 1.6)(F)),
            "w2": _w((lambda *s: torch.randn(*s, dtype=torch.bfloat16) * 0.8)(F, D) * (F ** -0.5)),
            "b2": _w((lambda *s: torch.randn(*s, dtype=torch.bfloat16) * 1.6)(D)),
        }
    _B_in = _B_setup()

    return {
        "A_x": _A_in["x"],
        "A_wqkv": _A_in["wqkv"],
        "A_wo": _A_in["wo"],
        "B_x": _B_in["x"],
        "B_w1": _B_in["w1"],
        "B_b1": _B_in["b1"],
        "B_w2": _B_in["w2"],
        "B_b2": _B_in["b2"],
    }

def reference(A_x, A_wqkv, A_wo, B_x, B_w1, B_b1, B_w2, B_b2):
    def _A_ref(x, wqkv, wo):
        B, S, D = x.shape
        H = 32
        Dh = D // H
        qkv = (lambda x, *d: x.permute(*d))((x @ wqkv).reshape(B, S, 3, H, Dh), 2, 0, 3, 1, 4)
        q, k, v = qkv[0], qkv[1], qkv[2]
        scores = torch.einsum("bhqd,bhkd->bhqk", q, k) * (Dh ** -0.5)
        p = _softmax(scores, axis=-1)
        o = torch.einsum("bhqk,bhkd->bhqd", p, v)
        return (lambda x, *d: x.permute(*d))(o, 0, 2, 1, 3).reshape(B, S, D) @ wo

    def _B_ref(x, w1, b1, w2, b2):
        y = _layernorm(x, axis=-1)
        h = _gelu(torch.einsum("bsd,df->bsf", y, w1) + b1)
        return torch.einsum("bsf,fd->bsd", h, w2) + b2

    x = A_x
    h = x + _A_ref(_layernorm(x, axis=-1), A_wqkv, A_wo)
    h2 = h + _B_ref(_layernorm(h, axis=-1), B_w1, B_b1, B_w2, B_b2)
    return h2
```

```asm
; @launch grid=(256,1,1) block=(512,1,1) lds=163840
.amdgcn_target "amdgcn-amd-amdhsa--gfx950"
.text
.globl sequential_preLN__mha_block__mixer_channel_mlp__prompt_kernel
.p2align 8
.type sequential_preLN__mha_block__mixer_channel_mlp__prompt_kernel,@function
sequential_preLN__mha_block__mixer_channel_mlp__prompt_kernel:
  s_cmp_ge_u32 s2, 256
  s_cbranch_scc1 ALL_end
  s_load_dwordx16 s[36:51], s[0:1], 0
  s_load_dwordx4 s[52:55], s[0:1], 64
  s_load_dwordx2 s[56:57], s[0:1], 80
  v_lshrrev_b32 v1, 6, v0
  v_and_b32 v2, 63, v0
  s_nop 0
  v_readfirstlane_b32 s3, v1
  s_and_b32 s26, s2, 7
  s_lshr_b32 s27, s2, 3
  s_and_b32 s24, s26, 1
  s_lshl_b32 s24, s24, 3
  s_and_b32 s28, s27, 7
  s_add_u32 s24, s24, s28
  s_lshr_b32 s25, s26, 1
  s_lshl_b32 s25, s25, 2
  s_lshr_b32 s28, s27, 3
  s_add_u32 s25, s25, s28
  s_mov_b32 s86, s24
  s_mov_b32 s87, s25
  s_lshr_b32 s89, s26, 1
  s_lshl_b32 s89, s89, 2
  s_and_b32 s28, s27, 3
  s_add_u32 s89, s89, s28
  s_and_b32 s90, s26, 1
  s_lshl_b32 s90, s90, 3
  s_lshr_b32 s28, s27, 2
  s_add_u32 s90, s90, s28
  v_lshlrev_b32 v3, 4, v2
  s_cmp_lt_u32 s3, 4
  s_cbranch_scc1 P1_cons
  s_sub_u32 s30, s3, 4
  v_lshrrev_b32 v6, 3, v2
  v_and_b32 v7, 7, v2
  v_lshrrev_b32 v8, 4, v2
  s_and_b32 s4, s30, 1
  s_lshl_b32 s4, s4, 2
  v_add_u32 v9, s4, v8
  v_xor_b32 v9, v9, v7
  v_lshlrev_b32 v9, 4, v9
  v_lshl_add_u32 v4, v6, 11, v9
  v_and_b32 v8, 1, v8
  v_lshlrev_b32 v8, 2, v8
  v_xor_b32 v8, v8, v7
  s_lshr_b32 s4, s4, 1
  v_xor_b32 v8, s4, v8
  v_lshlrev_b32 v8, 4, v8
  v_mul_u32_u24 v6, 6144, v6
  v_add_u32 v5, v6, v8
  s_lshl_b32 s31, s24, 18
  s_lshl_b32 s4, s30, 14
  s_add_u32 s31, s31, s4
  s_mul_i32 s32, s30, 49152
  s_lshl_b32 s4, s25, 7
  s_add_u32 s32, s32, s4
  s_lshl_b32 s34, s30, 10
  s_mov_b32 s33, s34
  s_mov_b32 s29, 0
  s_waitcnt lgkmcnt(0)
  s_mov_b32 s20, s56
  s_mov_b32 s21, s57
  s_mov_b32 s22, 0x10000000
  s_mov_b32 s23, 0x20000
  s_mov_b32 s12, s36
  s_mov_b32 s13, s37
  s_mov_b32 s14, 0x400000
  s_mov_b32 s15, 0x20000
  s_mov_b32 s16, s38
  s_mov_b32 s17, s39
  s_mov_b32 s18, 0x600000
  s_mov_b32 s19, 0x20000
  s_call_b64 s[92:93], P1_issue
  s_call_b64 s[92:93], P1_issue
  s_call_b64 s[92:93], P1_issue
  s_mul_i32 s5, s24, 393216
  s_add_u32 s5, s5, s32
  s_add_u32 m0, s34, 122880
  s_add_u32 s35, s5, 0
  buffer_load_dwordx4 v5, s[16:19], s35 offen lds
  s_add_u32 m0, s34, 126976
  s_add_u32 s35, s5, 196608
  buffer_load_dwordx4 v5, s[16:19], s35 offen lds
  s_add_u32 m0, s34, 131072
  s_add_u32 s35, s5, 2048
  buffer_load_dwordx4 v5, s[16:19], s35 offen lds
  s_add_u32 m0, s34, 135168
  s_add_u32 s35, s5, 198656
  buffer_load_dwordx4 v5, s[16:19], s35 offen lds
  s_add_u32 m0, s34, 139264
  s_add_u32 s35, s5, 4096
  buffer_load_dwordx4 v5, s[16:19], s35 offen lds
  s_add_u32 m0, s34, 143360
  s_add_u32 s35, s5, 200704
  buffer_load_dwordx4 v5, s[16:19], s35 offen lds
  v_lshrrev_b32 v6, 5, v2
  v_bfe_u32 v7, v2, 2, 2
  v_lshl_add_u32 v6, v6, 3, v7
  v_lshlrev_b32 v6, 7, v6
  s_and_b32 s4, s30, 1
  v_lshrrev_b32 v7, 1, v7
  v_xor_b32 v7, s4, v7
  v_lshl_add_u32 v6, v7, 6, v6
  v_bfe_u32 v7, v2, 4, 1
  v_lshrrev_b32 v8, 5, v2
  v_xor_b32 v7, v7, v8
  v_lshl_add_u32 v6, v7, 5, v6
  v_and_b32 v7, 3, v2
  v_lshl_add_u32 v6, v7, 3, v6
  s_lshr_b32 s5, s30, 1
  s_lshl_b32 s5, s5, 13
  s_add_u32 s5, s5, 122880
  v_add_u32 v7, s5, v6
  v_add_u32 v6, 139264, v6
  v_mov_b32 v40, 0
  v_mov_b32 v41, 0
  v_mov_b32 v42, 0
  v_mov_b32 v43, 0
  s_lshl_b32 s6, s25, 4
  s_add_u32 s6, s6, s24
  s_mul_i32 s6, s6, 768
  s_add_u32 s6, s6, 54067200
  s_lshl_b32 s7, s30, 7
  s_and_b32 s8, s30, 1
  s_lshl_b32 s8, s8, 7
  s_add_u32 s8, s8, 384
  v_mov_b32 v46, s7
  v_mov_b32 v47, s8
  v_cmp_lt_u32 vcc, 31, v2
  v_lshlrev_b32 v48, 2, v2
  s_nop 0
  v_cndmask_b32 v46, v46, v47, vcc
  v_add_u32 v48, v48, v46
  s_mov_b32 s96, s54
  s_mov_b32 s97, s55
  s_cmp_eq_u32 s30, 0
  s_cselect_b32 s98, 64, 0
  s_mov_b32 s99, 0x20000
  s_memrealtime s[8:9]
  s_waitcnt lgkmcnt(0)
  s_or_b32 s8, s8, 1
  v_mov_b32 v50, s8
  v_mov_b32 v51, 0
  v_mov_b32 v52, s8
  s_mov_b64 exec, 1
  buffer_atomic_cmpswap v[50:51], off, s[96:99], 0 sc0 sc1
  s_mov_b64 exec, -1
  v_and_b32 v53, 1, v2
  v_lshlrev_b32 v53, 3, v53
  s_lshl_b32 s8, s30, 4
  s_add_u32 s9, s8, 151616
  v_add_u32 v56, s9, v53
  s_lshl_b32 s9, s24, 10
  s_add_u32 s8, s8, s9
  s_lshl_b32 s9, s25, 6
  s_add_u32 s8, s8, s9
  s_add_u32 s11, s8, 54001664
  s_waitcnt vmcnt(27)
  s_waitcnt vmcnt(27)
  s_barrier
  ds_read_b64 v[54:55], v56
  s_mov_b64 exec, 3
  s_waitcnt lgkmcnt(0)
  buffer_store_dwordx2 v[54:55], v53, s[20:23], s11 offen sc1
  s_mov_b64 exec, -1
  s_waitcnt vmcnt(18)
  s_barrier
  s_call_b64 s[92:93], P1_issue
  s_waitcnt vmcnt(18)
  s_barrier
  s_call_b64 s[92:93], P1_issue
  s_waitcnt vmcnt(10)
  s_barrier
  s_call_b64 s[92:93], P1_issue
  s_cmp_lg_u32 s30, 0
  s_cbranch_scc1 P1_notag2
  v_cmp_eq_u32 vcc, 0, v50
  v_mov_b32 v51, 151552
  s_nop 0
  v_cndmask_b32 v50, v50, v52, vcc
  s_mov_b64 exec, 1
  ds_write_b32 v51, v50
  s_mov_b64 exec, -1
P1_notag2:
  ds_read_b64_tr_b16 v[8:9], v7 offset:0
  ds_read_b64_tr_b16 v[10:11], v7 offset:512
  ds_read_b64_tr_b16 v[12:13], v7 offset:2048
  ds_read_b64_tr_b16 v[14:15], v7 offset:2560
  ds_read_b64_tr_b16 v[16:17], v7 offset:4096
  ds_read_b64_tr_b16 v[18:19], v7 offset:4608
  ds_read_b64_tr_b16 v[20:21], v7 offset:6144
  ds_read_b64_tr_b16 v[22:23], v7 offset:6656
  ds_read_b64_tr_b16 v[24:25], v6 offset:0
  ds_read_b64_tr_b16 v[26:27], v6 offset:512
  ds_read_b64_tr_b16 v[28:29], v6 offset:2048
  ds_read_b64_tr_b16 v[30:31], v6 offset:2560
  ds_read_b64_tr_b16 v[32:33], v6 offset:4096
  ds_read_b64_tr_b16 v[34:35], v6 offset:4608
  ds_read_b64_tr_b16 v[36:37], v6 offset:6144
  ds_read_b64_tr_b16 v[38:39], v6 offset:6656
  s_waitcnt lgkmcnt(0)
  v_lshlrev_b32 v44, 16, v8
  v_and_b32 v45, 0xffff0000, v8
  v_add_f32 v40, v40, v44
  v_add_f32 v41, v41, v45
  v_lshlrev_b32 v44, 16, v24
  v_and_b32 v45, 0xffff0000, v24
  v_add_f32 v42, v42, v44
  v_add_f32 v43, v43, v45
  v_lshlrev_b32 v44, 16, v9
  v_and_b32 v45, 0xffff0000, v9
  v_add_f32 v40, v40, v44
  v_add_f32 v41, v41, v45
  v_lshlrev_b32 v44, 16, v25
  v_and_b32 v45, 0xffff0000, v25
  v_add_f32 v42, v42, v44
  v_add_f32 v43, v43, v45
  s_waitcnt vmcnt(10)
  s_barrier
  s_call_b64 s[92:93], P1_issue
  v_lshlrev_b32 v44, 16, v10
  v_and_b32 v45, 0xffff0000, v10
  v_add_f32 v40, v40, v44
  v_add_f32 v41, v41, v45
  v_lshlrev_b32 v44, 16, v26
  v_and_b32 v45, 0xffff0000, v26
  v_add_f32 v42, v42, v44
  v_add_f32 v43, v43, v45
  v_lshlrev_b32 v44, 16, v11
  v_and_b32 v45, 0xffff0000, v11
  v_add_f32 v40, v40, v44
  v_add_f32 v41, v41, v45
  v_lshlrev_b32 v44, 16, v27
  v_and_b32 v45, 0xffff0000, v27
  v_add_f32 v42, v42, v44
  v_add_f32 v43, v43, v45
  v_lshlrev_b32 v44, 16, v12
  v_and_b32 v45, 0xffff0000, v12
  v_add_f32 v40, v40, v44
  v_add_f32 v41, v41, v45
  v_lshlrev_b32 v44, 16, v28
  v_and_b32 v45, 0xffff0000, v28
  v_add_f32 v42, v42, v44
  v_add_f32 v43, v43, v45
  v_lshlrev_b32 v44, 16, v13
  v_and_b32 v45, 0xffff0000, v13
  v_add_f32 v40, v40, v44
  v_add_f32 v41, v41, v45
  v_lshlrev_b32 v44, 16, v29
  v_and_b32 v45, 0xffff0000, v29
  v_add_f32 v42, v42, v44
  v_add_f32 v43, v43, v45
  s_waitcnt vmcnt(10)
  s_barrier
  s_call_b64 s[92:93], P1_issue
  v_lshlrev_b32 v44, 16, v14
  v_and_b32 v45, 0xffff0000, v14
  v_add_f32 v40, v40, v44
  v_add_f32 v41, v41, v45
  v_lshlrev_b32 v44, 16, v30
  v_and_b32 v45, 0xffff0000, v30
  v_add_f32 v42, v42, v44
  v_add_f32 v43, v43, v45
  v_lshlrev_b32 v44, 16, v15
  v_and_b32 v45, 0xffff0000, v15
  v_add_f32 v40, v40, v44
  v_add_f32 v41, v41, v45
  v_lshlrev_b32 v44, 16, v31
  v_and_b32 v45, 0xffff0000, v31
  v_add_f32 v42, v42, v44
  v_add_f32 v43, v43, v45
  v_lshlrev_b32 v44, 16, v16
  v_and_b32 v45, 0xffff0000, v16
  v_add_f32 v40, v40, v44
  v_add_f32 v41, v41, v45
  v_lshlrev_b32 v44, 16, v32
  v_and_b32 v45, 0xffff0000, v32
  v_add_f32 v42, v42, v44
  v_add_f32 v43, v43, v45
  v_lshlrev_b32 v44, 16, v17
  v_and_b32 v45, 0xffff0000, v17
  v_add_f32 v40, v40, v44
  v_add_f32 v41, v41, v45
  v_lshlrev_b32 v44, 16, v33
  v_and_b32 v45, 0xffff0000, v33
  v_add_f32 v42, v42, v44
  v_add_f32 v43, v43, v45
  v_lshlrev_b32 v44, 16, v18
  v_and_b32 v45, 0xffff0000, v18
  v_add_f32 v40, v40, v44
  v_add_f32 v41, v41, v45
  v_lshlrev_b32 v44, 16, v34
  v_and_b32 v45, 0xffff0000, v34
  v_add_f32 v42, v42, v44
  v_add_f32 v43, v43, v45
  v_lshlrev_b32 v44, 16, v19
  v_and_b32 v45, 0xffff0000, v19
  v_add_f32 v40, v40, v44
  v_add_f32 v41, v41, v45
  v_lshlrev_b32 v44, 16, v35
  v_and_b32 v45, 0xffff0000, v35
  v_add_f32 v42, v42, v44
  v_add_f32 v43, v43, v45
  s_waitcnt vmcnt(10)
  s_barrier
  s_call_b64 s[92:93], P1_issue
  v_lshlrev_b32 v44, 16, v20
  v_and_b32 v45, 0xffff0000, v20
  v_add_f32 v40, v40, v44
  v_add_f32 v41, v41, v45
  v_lshlrev_b32 v44, 16, v36
  v_and_b32 v45, 0xffff0000, v36
  v_add_f32 v42, v42, v44
  v_add_f32 v43, v43, v45
  v_lshlrev_b32 v44, 16, v21
  v_and_b32 v45, 0xffff0000, v21
  v_add_f32 v40, v40, v44
  v_add_f32 v41, v41, v45
  v_lshlrev_b32 v44, 16, v37
  v_and_b32 v45, 0xffff0000, v37
  v_add_f32 v42, v42, v44
  v_add_f32 v43, v43, v45
  v_lshlrev_b32 v44, 16, v22
  v_and_b32 v45, 0xffff0000, v22
  v_add_f32 v40, v40, v44
  v_add_f32 v41, v41, v45
  v_lshlrev_b32 v44, 16, v38
  v_and_b32 v45, 0xffff0000, v38
  v_add_f32 v42, v42, v44
  v_add_f32 v43, v43, v45
  v_lshlrev_b32 v44, 16, v23
  v_and_b32 v45, 0xffff0000, v23
  v_add_f32 v40, v40, v44
  v_add_f32 v41, v41, v45
  v_lshlrev_b32 v44, 16, v39
  v_and_b32 v45, 0xffff0000, v39
  v_add_f32 v42, v42, v44
  v_add_f32 v43, v43, v45
  v_add_f32 v40, v40, v41
  v_add_f32 v42, v42, v43
  s_nop 1
  v_permlane32_swap_b32 v40, v42
  v_add_f32 v40, v40, v42
  buffer_store_dword v40, v48, s[20:23], s6 offen sc1
  v_mov_b32 v7, 151552
  ds_read_b32 v7, v7
  s_lshl_b32 s10, s25, 12
  s_lshl_b32 s5, s24, 4
  s_add_u32 s10, s10, s5
  s_lshl_b32 s5, s30, 2
  s_add_u32 s10, s10, s5
  s_add_u32 s10, s10, 55640320
  s_waitcnt lgkmcnt(0)
  v_readfirstlane_b32 s88, v7
  s_waitcnt vmcnt(11)
  s_barrier
  s_call_b64 s[92:93], P1_issue
  s_waitcnt vmcnt(10)
  s_barrier
  v_mov_b32 v7, s88
  s_mov_b64 exec, 1
  buffer_store_dword v7, off, s[20:23], s10 sc1
  s_mov_b64 exec, -1
  s_lshl_b32 s10, s24, 12
  s_lshl_b32 s5, s25, 4
  s_add_u32 s10, s10, s5
  s_lshl_b32 s5, s30, 2
  s_add_u32 s10, s10, s5
  s_add_u32 s10, s10, 55574528
  v_mov_b32 v7, s88
  s_mov_b64 exec, 1
  buffer_store_dword v7, off, s[20:23], s10 sc1
  s_mov_b64 exec, -1
  s_call_b64 s[92:93], P1_issue
  s_waitcnt vmcnt(12)
  s_barrier
  s_call_b64 s[92:93], P1_issue
  s_waitcnt vmcnt(10)
  s_barrier
  s_call_b64 s[92:93], P1_issue
  v_lshlrev_b32 v6, 2, v2
  s_lshl_b32 s8, s24, 12
  s_add_u32 s8, s8, 55574528
  s_lshl_b32 s9, s25, 12
  s_add_u32 s9, s9, 55640320
  s_waitcnt vmcnt(10)
  s_barrier
  s_call_b64 s[92:93], P1_issue
  buffer_load_dword v8, v6, s[20:23], s8 offen sc1
  buffer_load_dword v9, v6, s[20:23], s9 offen sc1
  v_and_b32 v26, 15, v2
  v_min_u32 v26, 11, v26
  v_lshrrev_b32 v27, 4, v2
  v_mul_u32_u24 v27, 3072, v27
  v_lshl_add_u32 v27, v26, 4, v27
  s_mul_i32 s10, s25, 12288
  s_mul_i32 s5, s30, 192
  s_add_u32 s10, s10, s5
  s_add_u32 s10, s10, 54067200
  v_and_b32 v7, 31, v2
  v_lshlrev_b32 v28, 3, v7
  s_lshl_b32 s11, s24, 10
  s_lshl_b32 s5, s30, 8
  s_add_u32 s11, s11, s5
  s_add_u32 s11, s11, 54001664
  s_waitcnt vmcnt(12)
  s_barrier
  s_call_b64 s[92:93], P1_issue
  s_waitcnt vmcnt(10)
  s_barrier
  s_call_b64 s[92:93], P1_issue
  s_mov_b32 s91, 200000
  v_cmp_ne_u32 vcc, s88, v8
  s_cbranch_vccz POK_1
PTOP_2:
  buffer_load_dword v8, v6, s[20:23], s8 offen sc1
  s_waitcnt vmcnt(0)
  v_cmp_ne_u32 vcc, s88, v8
  s_cbranch_vccz POK_1
  s_sleep 4
  s_sub_u32 s91, s91, 1
  s_cmp_lg_u32 s91, 0
  s_cbranch_scc1 PTOP_2
POK_1:
  s_mov_b32 s91, 200000
  v_cmp_ne_u32 vcc, s88, v9
  s_cbranch_vccz POK_3
PTOP_4:
  buffer_load_dword v9, v6, s[20:23], s9 offen sc1
  s_waitcnt vmcnt(0)
  v_cmp_ne_u32 vcc, s88, v9
  s_cbranch_vccz POK_3
  s_sleep 4
  s_sub_u32 s91, s91, 1
  s_cmp_lg_u32 s91, 0
  s_cbranch_scc1 PTOP_4
POK_3:
  buffer_load_dwordx4 v[8:11], v27, s[20:23], s10 offen offset:0 sc1
  buffer_load_dwordx4 v[12:15], v27, s[20:23], s10 offen offset:768 sc1
  buffer_load_dwordx4 v[16:19], v27, s[20:23], s10 offen offset:1536 sc1
  buffer_load_dwordx4 v[20:23], v27, s[20:23], s10 offen offset:2304 sc1
  buffer_load_dwordx2 v[24:25], v28, s[20:23], s11 offen sc1
  s_mul_i32 s5, s30, 192
  s_add_u32 s5, s5, 148480
  v_lshlrev_b32 v26, 4, v26
  v_add_u32 v26, s5, v26
  v_lshlrev_b32 v7, 2, v7
  s_lshl_b32 s5, s30, 7
  s_add_u32 s5, s5, 147456
  v_add_u32 v7, s5, v7
  s_waitcnt vmcnt(15)
  s_barrier
  s_waitcnt vmcnt(0)
  s_barrier
  v_add_f32 v8, v8, v12
  v_add_f32 v9, v9, v13
  v_add_f32 v10, v10, v14
  v_add_f32 v11, v11, v15
  v_add_f32 v8, v8, v16
  v_add_f32 v9, v9, v17
  v_add_f32 v10, v10, v18
  v_add_f32 v11, v11, v19
  v_add_f32 v8, v8, v20
  v_add_f32 v9, v9, v21
  v_add_f32 v10, v10, v22
  v_add_f32 v11, v11, v23
  ds_write_b32 v7, v24
  ds_write_b32 v7, v25 offset:512
  v_mov_b32 v12, v8
  v_mov_b32 v13, v9
  v_mov_b32 v14, v10
  v_mov_b32 v15, v11
  s_nop 0
  v_permlane32_swap_b32 v8, v12
  v_permlane32_swap_b32 v9, v13
  v_permlane32_swap_b32 v10, v14
  v_permlane32_swap_b32 v11, v15
  v_add_f32 v8, v8, v12
  v_add_f32 v9, v9, v13
  v_add_f32 v10, v10, v14
  v_add_f32 v11, v11, v15
  v_mov_b32 v12, v8
  v_mov_b32 v13, v9
  v_mov_b32 v14, v10
  v_mov_b32 v15, v11
  s_nop 0
  v_permlane16_swap_b32 v8, v12
  v_permlane16_swap_b32 v9, v13
  v_permlane16_swap_b32 v10, v14
  v_permlane16_swap_b32 v11, v15
  v_add_f32 v8, v8, v12
  v_add_f32 v9, v9, v13
  v_add_f32 v10, v10, v14
  v_add_f32 v11, v11, v15
  ds_write_b128 v26, v[8:11]
  s_waitcnt lgkmcnt(0)
  s_barrier
  s_branch P2_entry
P1_issue:
  s_lshl_b32 s4, s29, 7
  s_add_u32 s4, s4, s31
  s_mul_i32 s5, s29, 393216
  s_add_u32 s5, s5, s32
  s_add_u32 m0, s33, 0
  s_add_u32 s35, s4, 0
  buffer_load_dwordx4 v4, s[12:15], s35 offen lds
  s_add_u32 m0, s33, 4096
  s_add_u32 s35, s4, 65536
  buffer_load_dwordx4 v4, s[12:15], s35 offen lds
  s_add_u32 m0, s33, 8192
  s_add_u32 s35, s4, 131072
  buffer_load_dwordx4 v4, s[12:15], s35 offen lds
  s_add_u32 m0, s33, 12288
  s_add_u32 s35, s4, 196608
  buffer_load_dwordx4 v4, s[12:15], s35 offen lds
  s_add_u32 m0, s33, 16384
  s_add_u32 s35, s5, 0
  buffer_load_dwordx4 v5, s[16:19], s35 offen lds
  s_add_u32 m0, s33, 20480
  s_add_u32 s35, s5, 196608
  buffer_load_dwordx4 v5, s[16:19], s35 offen lds
  s_add_u32 m0, s33, 24576
  s_add_u32 s35, s5, 2048
  buffer_load_dwordx4 v5, s[16:19], s35 offen lds
  s_add_u32 m0, s33, 28672
  s_add_u32 s35, s5, 198656
  buffer_load_dwordx4 v5, s[16:19], s35 offen lds
  s_add_u32 m0, s33, 32768
  s_add_u32 s35, s5, 4096
  buffer_load_dwordx4 v5, s[16:19], s35 offen lds
  s_add_u32 m0, s33, 36864
  s_add_u32 s35, s5, 200704
  buffer_load_dwordx4 v5, s[16:19], s35 offen lds
  s_add_u32 s29, s29, 1
  s_and_b32 s29, s29, 15
  s_add_u32 s33, s33, 40960
  s_cmp_ge_u32 s33, 122880
  s_cselect_b32 s33, s34, s33
  s_setpc_b64 s[92:93]
P1_cons:
  s_waitcnt lgkmcnt(0)
  s_mov_b32 s20, s56
  s_mov_b32 s21, s57
  s_mov_b32 s22, 0x10000000
  s_mov_b32 s23, 0x20000
  s_mov_b32 s12, s36
  s_mov_b32 s13, s37
  s_mov_b32 s14, 0x400000
  s_mov_b32 s15, 0x20000
  s_mov_b32 s16, s54
  s_mov_b32 s17, s55
  s_mov_b32 s18, 0x100
  s_mov_b32 s19, 0x20000
  s_lshl_b32 s30, s24, 7
  s_lshl_b32 s4, s25, 3
  s_add_u32 s30, s30, s4
  s_lshl_b32 s4, s3, 1
  s_add_u32 s30, s30, s4
  s_lshl_b32 s4, s30, 11
  buffer_load_dwordx4 v[196:199], v3, s[12:15], s4 offen offset:0
  buffer_load_dwordx4 v[200:203], v3, s[12:15], s4 offen offset:1024
  buffer_load_dwordx4 v[204:207], v3, s[12:15], s4 offen offset:2048
  buffer_load_dwordx4 v[208:211], v3, s[12:15], s4 offen offset:3072
  s_getpc_b64 s[6:7]
CODE_REF:
  s_sub_u32 s6, s6, CODE_REF-sequential_preLN__mha_block__mixer_channel_mlp__prompt_kernel
  s_subb_u32 s7, s7, 0
  s_lshr_b32 s5, s2, 3
  s_lshl_b32 s5, s5, 2
  s_add_u32 s5, s5, s3
  s_lshl_b32 s5, s5, 8
  v_lshlrev_b32 v184, 2, v2
  v_add_u32 v184, s5, v184
  v_min_u32 v184, CODE_END-sequential_preLN__mha_block__mixer_channel_mlp__prompt_kernel-4, v184
  global_load_dword v185, v184, s[6:7]
  v_add_u32 v184, 32768, v184
  v_min_u32 v184, CODE_END-sequential_preLN__mha_block__mixer_channel_mlp__prompt_kernel-4, v184
  global_load_dword v186, v184, s[6:7]
  s_setprio 1
  s_lshr_b32 s31, s3, 1
  s_and_b32 s32, s3, 1
  v_and_b32 v184, 15, v2
  v_lshrrev_b32 v187, 4, v2
  v_bfe_u32 v188, v2, 1, 3
  v_xor_b32 v188, v187, v188
  s_lshl_b32 s4, s31, 13
  v_lshlrev_b32 v184, 7, v184
  v_add_u32 v184, s4, v184
  v_lshl_add_u32 v180, v188, 4, v184
  v_xor_b32 v181, 64, v180
  v_bfe_u32 v189, v2, 2, 2
  v_lshl_add_u32 v190, v187, 3, v189
  v_lshlrev_b32 v190, 7, v190
  v_lshrrev_b32 v191, 1, v189
  v_xor_b32 v191, s32, v191
  v_lshl_add_u32 v190, v191, 6, v190
  v_bfe_u32 v191, v2, 4, 1
  v_lshl_add_u32 v190, v191, 5, v190
  v_and_b32 v191, 3, v2
  v_lshl_add_u32 v190, v191, 3, v190
  v_add_u32 v182, 16384, v190
  v_xor_b32 v183, 32, v182
  v_mov_b32 v4, 0
  v_mov_b32 v5, 0
  v_mov_b32 v6, 0
  v_mov_b32 v7, 0
  v_mov_b32 v8, 0
  v_mov_b32 v9, 0
  v_mov_b32 v10, 0
  v_mov_b32 v11, 0
  v_mov_b32 v12, 0
  v_mov_b32 v13, 0
  v_mov_b32 v14, 0
  v_mov_b32 v15, 0
  v_mov_b32 v16, 0
  v_mov_b32 v17, 0
  v_mov_b32 v18, 0
  v_mov_b32 v19, 0
  v_mov_b32 v20, 0
  v_mov_b32 v21, 0
  v_mov_b32 v22, 0
  v_mov_b32 v23, 0
  v_mov_b32 v24, 0
  v_mov_b32 v25, 0
  v_mov_b32 v26, 0
  v_mov_b32 v27, 0
  v_mov_b32 v28, 0
  v_mov_b32 v29, 0
  v_mov_b32 v30, 0
  v_mov_b32 v31, 0
  v_mov_b32 v32, 0
  v_mov_b32 v33, 0
  v_mov_b32 v34, 0
  v_mov_b32 v35, 0
  v_mov_b32 v36, 0
  v_mov_b32 v37, 0
  v_mov_b32 v38, 0
  v_mov_b32 v39, 0
  v_mov_b32 v40, 0
  v_mov_b32 v41, 0
  v_mov_b32 v42, 0
  v_mov_b32 v43, 0
  v_mov_b32 v44, 0
  v_mov_b32 v45, 0
  v_mov_b32 v46, 0
  v_mov_b32 v47, 0
  v_mov_b32 v48, 0
  v_mov_b32 v49, 0
  v_mov_b32 v50, 0
  v_mov_b32 v51, 0
  v_mov_b32 v52, 0
  v_mov_b32 v53, 0
  v_mov_b32 v54, 0
  v_mov_b32 v55, 0
  v_mov_b32 v56, 0
  v_mov_b32 v57, 0
  v_mov_b32 v58, 0
  v_mov_b32 v59, 0
  v_mov_b32 v60, 0
  v_mov_b32 v61, 0
  v_mov_b32 v62, 0
  v_mov_b32 v63, 0
  v_mov_b32 v64, 0
  v_mov_b32 v65, 0
  v_mov_b32 v66, 0
  v_mov_b32 v67, 0
  v_mov_b32 v68, 0
  v_mov_b32 v69, 0
  v_mov_b32 v70, 0
  v_mov_b32 v71, 0
  v_mov_b32 v72, 0
  v_mov_b32 v73, 0
  v_mov_b32 v74, 0
  v_mov_b32 v75, 0
  v_mov_b32 v76, 0
  v_mov_b32 v77, 0
  v_mov_b32 v78, 0
  v_mov_b32 v79, 0
  v_mov_b32 v80, 0
  v_mov_b32 v81, 0
  v_mov_b32 v82, 0
  v_mov_b32 v83, 0
  v_mov_b32 v84, 0
  v_mov_b32 v85, 0
  v_mov_b32 v86, 0
  v_mov_b32 v87, 0
  v_mov_b32 v88, 0
  v_mov_b32 v89, 0
  v_mov_b32 v90, 0
  v_mov_b32 v91, 0
  v_mov_b32 v92, 0
  v_mov_b32 v93, 0
  v_mov_b32 v94, 0
  v_mov_b32 v95, 0
  v_mov_b32 v96, 0
  v_mov_b32 v97, 0
  v_mov_b32 v98, 0
  v_mov_b32 v99, 0
  v_mov_b32 v140, 0
  v_mov_b32 v141, 0
  v_mov_b32 v142, 0
  v_mov_b32 v143, 0
  v_mov_b32 v144, 0
  v_mov_b32 v145, 0
  v_mov_b32 v146, 0
  v_mov_b32 v147, 0
  v_mov_b32 v148, 0
  v_mov_b32 v149, 0
  v_mov_b32 v150, 0
  v_mov_b32 v151, 0
  v_mov_b32 v152, 0
  v_mov_b32 v153, 0
  v_mov_b32 v154, 0
  v_mov_b32 v155, 0
  v_mov_b32 v156, 0
  v_mov_b32 v157, 0
  v_mov_b32 v158, 0
  v_mov_b32 v159, 0
  v_mov_b32 v160, 0
  v_mov_b32 v161, 0
  v_mov_b32 v162, 0
  v_mov_b32 v163, 0
  v_mov_b32 v164, 0
  v_mov_b32 v165, 0
  v_mov_b32 v166, 0
  v_mov_b32 v167, 0
  v_mov_b32 v168, 0
  v_mov_b32 v169, 0
  v_mov_b32 v170, 0
  v_mov_b32 v171, 0
  v_mov_b32 v172, 0
  v_mov_b32 v173, 0
  v_mov_b32 v174, 0
  v_mov_b32 v175, 0
  v_mov_b32 v176, 0
  v_mov_b32 v177, 0
  v_mov_b32 v178, 0
  v_mov_b32 v179, 0
  s_mov_b32 s34, 0
  s_mov_b32 s35, 0
  s_mov_b32 s58, 0xfffec000
  s_mov_b32 s59, 40960
  v_mov_b32 v184, 0
  v_mov_b32 v187, 0
  v_mov_b32 v188, 0
  v_mov_b32 v189, 0
  v_mov_b32 v190, 0x3f803f80
  s_waitcnt vmcnt(2)
  v_dot2c_f32_bf16 v184, v196, v190
  v_dot2c_f32_bf16 v187, v196, v196
  v_dot2c_f32_bf16 v188, v204, v190
  v_dot2c_f32_bf16 v189, v204, v204
  v_dot2c_f32_bf16 v184, v197, v190
  v_dot2c_f32_bf16 v187, v197, v197
  v_dot2c_f32_bf16 v188, v205, v190
  v_dot2c_f32_bf16 v189, v205, v205
  v_dot2c_f32_bf16 v184, v198, v190
  v_dot2c_f32_bf16 v187, v198, v198
  v_dot2c_f32_bf16 v188, v206, v190
  v_dot2c_f32_bf16 v189, v206, v206
  v_dot2c_f32_bf16 v184, v199, v190
  v_dot2c_f32_bf16 v187, v199, v199
  v_dot2c_f32_bf16 v188, v207, v190
  v_dot2c_f32_bf16 v189, v207, v207
  v_dot2c_f32_bf16 v184, v200, v190
  v_dot2c_f32_bf16 v187, v200, v200
  v_dot2c_f32_bf16 v188, v208, v190
  v_dot2c_f32_bf16 v189, v208, v208
  v_dot2c_f32_bf16 v184, v201, v190
  v_dot2c_f32_bf16 v187, v201, v201
  v_dot2c_f32_bf16 v188, v209, v190
  v_dot2c_f32_bf16 v189, v209, v209
  v_dot2c_f32_bf16 v184, v202, v190
  v_dot2c_f32_bf16 v187, v202, v202
  v_dot2c_f32_bf16 v188, v210, v190
  v_dot2c_f32_bf16 v189, v210, v210
  v_dot2c_f32_bf16 v184, v203, v190
  v_dot2c_f32_bf16 v187, v203, v203
  v_dot2c_f32_bf16 v188, v211, v190
  v_dot2c_f32_bf16 v189, v211, v211
  s_nop 2
  v_permlane32_swap_b32 v184, v188
  v_permlane32_swap_b32 v187, v189
  v_add_f32 v184, v184, v188
  v_add_f32 v187, v187, v189
  s_nop 1
  v_permlane16_swap_b32 v184, v187
  v_add_f32 v184, v184, v187
  s_nop 1
  v_add_f32_dpp v184, v184, v184 quad_perm:[1,0,3,2] row_mask:0xf bank_mask:0xf
  s_nop 1
  v_add_f32_dpp v184, v184, v184 quad_perm:[2,3,0,1] row_mask:0xf bank_mask:0xf
  s_nop 1
  v_add_f32_dpp v184, v184, v184 row_half_mirror row_mask:0xf bank_mask:0xf
  s_nop 1
  v_add_f32_dpp v184, v184, v184 row_mirror row_mask:0xf bank_mask:0xf
  v_mov_b32 v187, v184
  s_nop 1
  v_permlane16_swap_b32 v184, v187
  v_mul_f32 v184, 0x3a800000, v184
  v_mul_f32 v187, 0x3a800000, v187
  v_fma_f32 v187, -v184, v184, v187
  v_max_f32 v187, 0, v187
  v_add_f32 v187, 0x3727c5ac, v187
  v_rsq_f32 v188, v187
  s_nop 0
  v_mul_f32 v189, v184, v188
  v_sub_f32 v189, 0, v189
  v_lshrrev_b32 v190, 5, v2
  v_lshlrev_b32 v190, 3, v190
  s_lshl_b32 s4, s3, 4
  s_add_u32 s4, s4, 151616
  v_add_u32 v190, s4, v190
  ds_write_b64 v190, v[188:189]
P1_cloop:
  s_waitcnt lgkmcnt(0)
  s_barrier
  v_mfma_f32_16x16x32_bf16 v[4:7], v[156:159], v[140:143], v[4:7]
  ds_read_b128 v[100:103], v180 offset:0
  v_mfma_f32_16x16x32_bf16 v[12:15], v[156:159], v[144:147], v[12:15]
  ds_read_b64_tr_b16 v[116:117], v182 offset:0
  v_mfma_f32_16x16x32_bf16 v[20:23], v[156:159], v[148:151], v[20:23]
  ds_read_b64_tr_b16 v[118:119], v182 offset:512
  v_mfma_f32_16x16x32_bf16 v[28:31], v[156:159], v[152:155], v[28:31]
  ds_read_b128 v[104:107], v180 offset:2048
  v_mfma_f32_16x16x32_bf16 v[32:35], v[160:163], v[152:155], v[32:35]
  ds_read_b128 v[108:111], v180 offset:4096
  v_mfma_f32_16x16x32_bf16 v[24:27], v[160:163], v[148:151], v[24:27]
  ds_read_b128 v[112:115], v180 offset:6144
  v_mfma_f32_16x16x32_bf16 v[16:19], v[160:163], v[144:147], v[16:19]
  ds_read_b64_tr_b16 v[120:121], v183 offset:0
  v_mfma_f32_16x16x32_bf16 v[8:11], v[160:163], v[140:143], v[8:11]
  ds_read_b64_tr_b16 v[122:123], v183 offset:512
  v_mfma_f32_16x16x32_bf16 v[36:39], v[164:167], v[140:143], v[36:39]
  ds_read_b64_tr_b16 v[124:125], v182 offset:8192
  v_mfma_f32_16x16x32_bf16 v[44:47], v[164:167], v[144:147], v[44:47]
  ds_read_b64_tr_b16 v[126:127], v182 offset:8704
  v_mfma_f32_16x16x32_bf16 v[52:55], v[164:167], v[148:151], v[52:55]
  ds_read_b64_tr_b16 v[128:129], v183 offset:8192
  v_mfma_f32_16x16x32_bf16 v[60:63], v[164:167], v[152:155], v[60:63]
  ds_read_b64_tr_b16 v[130:131], v183 offset:8704
  v_mfma_f32_16x16x32_bf16 v[64:67], v[168:171], v[152:155], v[64:67]
  ds_read_b64_tr_b16 v[132:133], v182 offset:16384
  v_mfma_f32_16x16x32_bf16 v[56:59], v[168:171], v[148:151], v[56:59]
  ds_read_b64_tr_b16 v[134:135], v182 offset:16896
  v_mfma_f32_16x16x32_bf16 v[48:51], v[168:171], v[144:147], v[48:51]
  ds_read_b64_tr_b16 v[136:137], v183 offset:16384
  v_mfma_f32_16x16x32_bf16 v[40:43], v[168:171], v[140:143], v[40:43]
  ds_read_b64_tr_b16 v[138:139], v183 offset:16896
  v_mfma_f32_16x16x32_bf16 v[68:71], v[140:143], v[172:175], v[68:71]
  s_add_u32 s34, s34, 1
  v_mfma_f32_16x16x32_bf16 v[72:75], v[144:147], v[172:175], v[72:75]
  s_cmp_eq_u32 s34, 3
  v_mfma_f32_16x16x32_bf16 v[76:79], v[148:151], v[172:175], v[76:79]
  s_cselect_b32 s33, s58, s59
  v_mfma_f32_16x16x32_bf16 v[80:83], v[152:155], v[172:175], v[80:83]
  s_cselect_b32 s34, 0, s34
  v_mfma_f32_16x16x32_bf16 v[96:99], v[152:155], v[176:179], v[96:99]
  v_mfma_f32_16x16x32_bf16 v[92:95], v[148:151], v[176:179], v[92:95]
  v_mfma_f32_16x16x32_bf16 v[88:91], v[144:147], v[176:179], v[88:91]
  v_mfma_f32_16x16x32_bf16 v[84:87], v[140:143], v[176:179], v[84:87]
  s_waitcnt lgkmcnt(0)
  v_mfma_f32_16x16x32_bf16 v[4:7], v[116:119], v[100:103], v[4:7]
  ds_read_b128 v[140:143], v181 offset:0
  v_mfma_f32_16x16x32_bf16 v[12:15], v[116:119], v[104:107], v[12:15]
  ds_read_b64_tr_b16 v[156:157], v182 offset:4096
  v_mfma_f32_16x16x32_bf16 v[20:23], v[116:119], v[108:111], v[20:23]
  ds_read_b64_tr_b16 v[158:159], v182 offset:4608
  v_mfma_f32_16x16x32_bf16 v[28:31], v[116:119], v[112:115], v[28:31]
  ds_read_b128 v[144:147], v181 offset:2048
  v_mfma_f32_16x16x32_bf16 v[32:35], v[120:123], v[112:115], v[32:35]
  ds_read_b128 v[148:151], v181 offset:4096
  v_mfma_f32_16x16x32_bf16 v[24:27], v[120:123], v[108:111], v[24:27]
  ds_read_b128 v[152:155], v181 offset:6144
  v_mfma_f32_16x16x32_bf16 v[16:19], v[120:123], v[104:107], v[16:19]
  ds_read_b64_tr_b16 v[160:161], v183 offset:4096
  v_mfma_f32_16x16x32_bf16 v[8:11], v[120:123], v[100:103], v[8:11]
  ds_read_b64_tr_b16 v[162:163], v183 offset:4608
  v_mfma_f32_16x16x32_bf16 v[36:39], v[124:127], v[100:103], v[36:39]
  ds_read_b64_tr_b16 v[164:165], v182 offset:12288
  v_mfma_f32_16x16x32_bf16 v[44:47], v[124:127], v[104:107], v[44:47]
  ds_read_b64_tr_b16 v[166:167], v182 offset:12800
  v_mfma_f32_16x16x32_bf16 v[52:55], v[124:127], v[108:111], v[52:55]
  ds_read_b64_tr_b16 v[168:169], v183 offset:12288
  v_mfma_f32_16x16x32_bf16 v[60:63], v[124:127], v[112:115], v[60:63]
  ds_read_b64_tr_b16 v[170:171], v183 offset:12800
  v_mfma_f32_16x16x32_bf16 v[64:67], v[128:131], v[112:115], v[64:67]
  ds_read_b64_tr_b16 v[172:173], v182 offset:20480
  v_mfma_f32_16x16x32_bf16 v[56:59], v[128:131], v[108:111], v[56:59]
  ds_read_b64_tr_b16 v[174:175], v182 offset:20992
  v_mfma_f32_16x16x32_bf16 v[48:51], v[128:131], v[104:107], v[48:51]
  ds_read_b64_tr_b16 v[176:177], v183 offset:20480
  v_mfma_f32_16x16x32_bf16 v[40:43], v[128:131], v[100:103], v[40:43]
  ds_read_b64_tr_b16 v[178:179], v183 offset:20992
  v_mfma_f32_16x16x32_bf16 v[68:71], v[100:103], v[132:135], v[68:71]
  v_add_u32 v180, s33, v180
  v_mfma_f32_16x16x32_bf16 v[72:75], v[104:107], v[132:135], v[72:75]
  v_add_u32 v181, s33, v181
  v_mfma_f32_16x16x32_bf16 v[76:79], v[108:111], v[132:135], v[76:79]
  v_add_u32 v182, s33, v182
  v_mfma_f32_16x16x32_bf16 v[80:83], v[112:115], v[132:135], v[80:83]
  v_add_u32 v183, s33, v183
  v_mfma_f32_16x16x32_bf16 v[96:99], v[112:115], v[136:139], v[96:99]
  s_add_u32 s35, s35, 1
  v_mfma_f32_16x16x32_bf16 v[92:95], v[108:111], v[136:139], v[92:95]
  s_cmp_lg_u32 s35, 16
  v_mfma_f32_16x16x32_bf16 v[88:91], v[104:107], v[136:139], v[88:91]
  v_mfma_f32_16x16x32_bf16 v[84:87], v[100:103], v[136:139], v[84:87]
  s_cbranch_scc1 P1_cloop
  s_waitcnt vmcnt(0) lgkmcnt(0)
  s_barrier
  v_mfma_f32_16x16x32_bf16 v[4:7], v[156:159], v[140:143], v[4:7]
  v_and_b32 v184, 15, v2
  v_lshrrev_b32 v185, 4, v2
  v_mfma_f32_16x16x32_bf16 v[12:15], v[156:159], v[144:147], v[12:15]
  v_lshlrev_b32 v186, 2, v184
  v_lshlrev_b32 v187, 4, v185
  v_mfma_f32_16x16x32_bf16 v[20:23], v[156:159], v[148:151], v[20:23]
  s_lshl_b32 s4, s31, 8
  s_add_u32 s4, s4, 147456
  v_mfma_f32_16x16x32_bf16 v[28:31], v[156:159], v[152:155], v[28:31]
  s_lshl_b32 s5, s32, 7
  s_add_u32 s5, s5, 148480
  v_mfma_f32_16x16x32_bf16 v[32:35], v[160:163], v[152:155], v[32:35]
  v_add_u32 v188, s4, v186
  v_add_u32 v189, s5, v187
  v_mfma_f32_16x16x32_bf16 v[24:27], v[160:163], v[148:151], v[24:27]
  v_add_u32 v190, s5, v186
  v_add_u32 v191, s4, v187
  v_mfma_f32_16x16x32_bf16 v[16:19], v[160:163], v[144:147], v[16:19]
  ds_read2_b32 v[196:197], v188 offset0:0 offset1:128
  ds_read2_b32 v[198:199], v188 offset0:16 offset1:144
  v_mfma_f32_16x16x32_bf16 v[8:11], v[160:163], v[140:143], v[8:11]
  ds_read2_b32 v[200:201], v188 offset0:32 offset1:160
  ds_read2_b32 v[202:203], v188 offset0:48 offset1:176
  v_mfma_f32_16x16x32_bf16 v[36:39], v[164:167], v[140:143], v[36:39]
  ds_read_b128 v[220:223], v189 offset:256
  ds_read_b128 v[224:227], v189 offset:320
  v_mfma_f32_16x16x32_bf16 v[44:47], v[164:167], v[144:147], v[44:47]
  ds_read_b128 v[212:215], v189 offset:0
  ds_read_b128 v[216:219], v189 offset:64
  v_mfma_f32_16x16x32_bf16 v[52:55], v[164:167], v[148:151], v[52:55]
  ds_read2_b32 v[228:229], v190 offset0:128 offset1:144
  v_mov_b32 v192, 151552
  v_mfma_f32_16x16x32_bf16 v[60:63], v[164:167], v[152:155], v[60:63]
  ds_read_b32 v192, v192
  v_lshlrev_b32 v230, 9, v185
  v_mfma_f32_16x16x32_bf16 v[64:67], v[168:171], v[152:155], v[64:67]
  v_lshl_add_u32 v230, v184, 4, v230
  v_and_b32 v231, 1, v185
  v_mfma_f32_16x16x32_bf16 v[56:59], v[168:171], v[148:151], v[56:59]
  v_lshlrev_b32 v231, 10, v231
  v_lshrrev_b32 v185, 1, v185
  v_mfma_f32_16x16x32_bf16 v[48:51], v[168:171], v[144:147], v[48:51]
  v_lshl_add_u32 v231, v185, 9, v231
  v_lshl_add_u32 v231, v184, 4, v231
  v_mfma_f32_16x16x32_bf16 v[40:43], v[168:171], v[140:143], v[40:43]
  v_mfma_f32_16x16x32_bf16 v[68:71], v[140:143], v[172:175], v[68:71]
  v_mfma_f32_16x16x32_bf16 v[72:75], v[144:147], v[172:175], v[72:75]
  v_mfma_f32_16x16x32_bf16 v[76:79], v[148:151], v[172:175], v[76:79]
  v_mfma_f32_16x16x32_bf16 v[80:83], v[152:155], v[172:175], v[80:83]
  v_mfma_f32_16x16x32_bf16 v[96:99], v[152:155], v[176:179], v[96:99]
  v_mfma_f32_16x16x32_bf16 v[92:95], v[148:151], v[176:179], v[92:95]
  v_mfma_f32_16x16x32_bf16 v[88:91], v[144:147], v[176:179], v[88:91]
  v_mfma_f32_16x16x32_bf16 v[84:87], v[140:143], v[176:179], v[84:87]
  s_lshl_b32 s8, s25, 1
  s_add_u32 s8, s8, s32
  s_lshl_b32 s8, s8, 6
  s_lshl_b32 s9, s24, 2
  s_add_u32 s8, s8, s9
  s_lshl_b32 s9, s31, 1
  s_add_u32 s8, s8, s9
  s_lshl_b32 s11, s8, 12
  s_add_u32 s11, s11, 4194304
  s_add_u32 s9, s11, 4096
  s_lshl_b32 s4, s32, 2
  s_lshl_b32 s5, s31, 1
  s_add_u32 s4, s4, s5
  s_lshl_b32 s5, s4, 12
  v_add_u32 v232, s5, v230
  v_add_u32 v234, s5, v231
  s_add_u32 s5, s5, 133120
  v_add_u32 v233, s5, v230
  s_waitcnt lgkmcnt(0)
  v_readfirstlane_b32 s88, v192
  ds_read_b128 v[100:103], v191 offset:0
  ds_read_b128 v[116:119], v191 offset:512
  ds_read_b128 v[104:107], v191 offset:64
  ds_read_b128 v[120:123], v191 offset:576
  ds_read_b128 v[108:111], v191 offset:128
  ds_read_b128 v[124:127], v191 offset:640
  ds_read_b128 v[112:115], v191 offset:192
  ds_read_b128 v[128:131], v191 offset:704
  v_mul_f32 v204, 0x3e8293ee, v196
  v_mul_f32 v205, 0x3e8293ee, v197
  v_mul_f32 v206, 0x3e8293ee, v198
  v_mul_f32 v207, 0x3e8293ee, v199
  v_mul_f32 v208, 0x3e8293ee, v200
  v_mul_f32 v209, 0x3e8293ee, v201
  v_mul_f32 v210, 0x3e8293ee, v202
  v_mul_f32 v211, 0x3e8293ee, v203
  v_pk_mul_f32 v[36:37], v[36:37], v[196:197] op_sel:[0,0] op_sel_hi:[1,0]
  v_pk_mul_f32 v[38:39], v[38:39], v[196:197] op_sel:[0,0] op_sel_hi:[1,0]
  v_pk_mul_f32 v[40:41], v[40:41], v[196:197] op_sel:[0,0] op_sel_hi:[1,0]
  v_pk_mul_f32 v[42:43], v[42:43], v[196:197] op_sel:[0,0] op_sel_hi:[1,0]
  v_pk_fma_f32 v[36:37], v[220:221], v[196:197], v[36:37] op_sel:[0,1,0] op_sel_hi:[1,1,1]
  v_pk_fma_f32 v[38:39], v[222:223], v[196:197], v[38:39] op_sel:[0,1,0] op_sel_hi:[1,1,1]
  v_pk_fma_f32 v[40:41], v[224:225], v[196:197], v[40:41] op_sel:[0,1,0] op_sel_hi:[1,1,1]
  v_pk_fma_f32 v[42:43], v[226:227], v[196:197], v[42:43] op_sel:[0,1,0] op_sel_hi:[1,1,1]
  v_cvt_pk_bf16_f32 v36, v36, v37
  v_cvt_pk_bf16_f32 v37, v38, v39
  v_cvt_pk_bf16_f32 v38, v40, v41
  v_cvt_pk_bf16_f32 v39, v42, v43
  buffer_store_dwordx4 v[36:39], v230, s[20:23], s11 offen offset:0 sc1
  ds_write_b128 v232, v[36:39] offset:0
  v_pk_mul_f32 v[44:45], v[44:45], v[198:199] op_sel:[0,0] op_sel_hi:[1,0]
  v_pk_mul_f32 v[46:47], v[46:47], v[198:199] op_sel:[0,0] op_sel_hi:[1,0]
  v_pk_mul_f32 v[48:49], v[48:49], v[198:199] op_sel:[0,0] op_sel_hi:[1,0]
  v_pk_mul_f32 v[50:51], v[50:51], v[198:199] op_sel:[0,0] op_sel_hi:[1,0]
  v_pk_fma_f32 v[44:45], v[220:221], v[198:199], v[44:45] op_sel:[0,1,0] op_sel_hi:[1,1,1]
  v_pk_fma_f32 v[46:47], v[222:223], v[198:199], v[46:47] op_sel:[0,1,0] op_sel_hi:[1,1,1]
  v_pk_fma_f32 v[48:49], v[224:225], v[198:199], v[48:49] op_sel:[0,1,0] op_sel_hi:[1,1,1]
  v_pk_fma_f32 v[50:51], v[226:227], v[198:199], v[50:51] op_sel:[0,1,0] op_sel_hi:[1,1,1]
  v_cvt_pk_bf16_f32 v44, v44, v45
  v_cvt_pk_bf16_f32 v45, v46, v47
  v_cvt_pk_bf16_f32 v46, v48, v49
  v_cvt_pk_bf16_f32 v47, v50, v51
  buffer_store_dwordx4 v[44:47], v230, s[20:23], s11 offen offset:256 sc1
  ds_write_b128 v232, v[44:47] offset:256
  v_pk_mul_f32 v[52:53], v[52:53], v[200:201] op_sel:[0,0] op_sel_hi:[1,0]
  v_pk_mul_f32 v[54:55], v[54:55], v[200:201] op_sel:[0,0] op_sel_hi:[1,0]
  v_pk_mul_f32 v[56:57], v[56:57], v[200:201] op_sel:[0,0] op_sel_hi:[1,0]
  v_pk_mul_f32 v[58:59], v[58:59], v[200:201] op_sel:[0,0] op_sel_hi:[1,0]
  v_pk_fma_f32 v[52:53], v[220:221], v[200:201], v[52:53] op_sel:[0,1,0] op_sel_hi:[1,1,1]
  v_pk_fma_f32 v[54:55], v[222:223], v[200:201], v[54:55] op_sel:[0,1,0] op_sel_hi:[1,1,1]
  v_pk_fma_f32 v[56:57], v[224:225], v[200:201], v[56:57] op_sel:[0,1,0] op_sel_hi:[1,1,1]
  v_pk_fma_f32 v[58:59], v[226:227], v[200:201], v[58:59] op_sel:[0,1,0] op_sel_hi:[1,1,1]
  v_cvt_pk_bf16_f32 v52, v52, v53
  v_cvt_pk_bf16_f32 v53, v54, v55
  v_cvt_pk_bf16_f32 v54, v56, v57
  v_cvt_pk_bf16_f32 v55, v58, v59
  buffer_store_dwordx4 v[52:55], v230, s[20:23], s9 offen offset:0 sc1
  ds_write_b128 v232, v[52:55] offset:4096
  v_pk_mul_f32 v[60:61], v[60:61], v[202:203] op_sel:[0,0] op_sel_hi:[1,0]
  v_pk_mul_f32 v[62:63], v[62:63], v[202:203] op_sel:[0,0] op_sel_hi:[1,0]
  v_pk_mul_f32 v[64:65], v[64:65], v[202:203] op_sel:[0,0] op_sel_hi:[1,0]
  v_pk_mul_f32 v[66:67], v[66:67], v[202:203] op_sel:[0,0] op_sel_hi:[1,0]
  v_pk_fma_f32 v[60:61], v[220:221], v[202:203], v[60:61] op_sel:[0,1,0] op_sel_hi:[1,1,1]
  v_pk_fma_f32 v[62:63], v[222:223], v[202:203], v[62:63] op_sel:[0,1,0] op_sel_hi:[1,1,1]
  v_pk_fma_f32 v[64:65], v[224:225], v[202:203], v[64:65] op_sel:[0,1,0] op_sel_hi:[1,1,1]
  v_pk_fma_f32 v[66:67], v[226:227], v[202:203], v[66:67] op_sel:[0,1,0] op_sel_hi:[1,1,1]
  v_cvt_pk_bf16_f32 v60, v60, v61
  v_cvt_pk_bf16_f32 v61, v62, v63
  v_cvt_pk_bf16_f32 v62, v64, v65
  v_cvt_pk_bf16_f32 v63, v66, v67
  buffer_store_dwordx4 v[60:63], v230, s[20:23], s9 offen offset:256 sc1
  ds_write_b128 v232, v[60:63] offset:4352
  s_waitcnt lgkmcnt(4)
  v_pk_mul_f32 v[68:69], v[68:69], v[100:101]
  v_pk_mul_f32 v[70:71], v[70:71], v[102:103]
  v_pk_mul_f32 v[72:73], v[72:73], v[104:105]
  v_pk_mul_f32 v[74:75], v[74:75], v[106:107]
  v_pk_fma_f32 v[68:69], v[116:117], v[228:229], v[68:69] op_sel:[0,0,0] op_sel_hi:[1,0,1]
  v_pk_fma_f32 v[70:71], v[118:119], v[228:229], v[70:71] op_sel:[0,0,0] op_sel_hi:[1,0,1]
  v_pk_fma_f32 v[72:73], v[120:121], v[228:229], v[72:73] op_sel:[0,0,0] op_sel_hi:[1,0,1]
  v_pk_fma_f32 v[74:75], v[122:123], v[228:229], v[74:75] op_sel:[0,0,0] op_sel_hi:[1,0,1]
  v_cvt_pk_bf16_f32 v68, v68, v69
  v_cvt_pk_bf16_f32 v69, v70, v71
  v_cvt_pk_bf16_f32 v70, v72, v73
  v_cvt_pk_bf16_f32 v71, v74, v75
  v_pk_mul_f32 v[84:85], v[84:85], v[100:101]
  v_pk_mul_f32 v[86:87], v[86:87], v[102:103]
  v_pk_mul_f32 v[88:89], v[88:89], v[104:105]
  v_pk_mul_f32 v[90:91], v[90:91], v[106:107]
  v_pk_fma_f32 v[84:85], v[116:117], v[228:229], v[84:85] op_sel:[0,1,0] op_sel_hi:[1,1,1]
  v_pk_fma_f32 v[86:87], v[118:119], v[228:229], v[86:87] op_sel:[0,1,0] op_sel_hi:[1,1,1]
  v_pk_fma_f32 v[88:89], v[120:121], v[228:229], v[88:89] op_sel:[0,1,0] op_sel_hi:[1,1,1]
  v_pk_fma_f32 v[90:91], v[122:123], v[228:229], v[90:91] op_sel:[0,1,0] op_sel_hi:[1,1,1]
  v_permlane16_swap_b32 v68, v70
  v_permlane16_swap_b32 v69, v71
  buffer_store_dwordx4 v[68:71], v231, s[20:23], s11 offen offset:2048 sc1
  ds_write_b128 v234, v[68:71] offset:2048
  v_cvt_pk_bf16_f32 v84, v84, v85
  v_cvt_pk_bf16_f32 v85, v86, v87
  v_cvt_pk_bf16_f32 v86, v88, v89
  v_cvt_pk_bf16_f32 v87, v90, v91
  v_pk_mul_f32 v[76:77], v[76:77], v[108:109]
  v_pk_mul_f32 v[78:79], v[78:79], v[110:111]
  v_pk_mul_f32 v[80:81], v[80:81], v[112:113]
  v_pk_mul_f32 v[82:83], v[82:83], v[114:115]
  v_pk_fma_f32 v[76:77], v[124:125], v[228:229], v[76:77] op_sel:[0,0,0] op_sel_hi:[1,0,1]
  v_pk_fma_f32 v[78:79], v[126:127], v[228:229], v[78:79] op_sel:[0,0,0] op_sel_hi:[1,0,1]
  v_pk_fma_f32 v[80:81], v[128:129], v[228:229], v[80:81] op_sel:[0,0,0] op_sel_hi:[1,0,1]
  v_pk_fma_f32 v[82:83], v[130:131], v[228:229], v[82:83] op_sel:[0,0,0] op_sel_hi:[1,0,1]
  v_permlane16_swap_b32 v84, v86
  v_permlane16_swap_b32 v85, v87
  buffer_store_dwordx4 v[84:87], v231, s[20:23], s11 offen offset:2304 sc1
  ds_write_b128 v234, v[84:87] offset:2304
  v_cvt_pk_bf16_f32 v76, v76, v77
  v_cvt_pk_bf16_f32 v77, v78, v79
  v_cvt_pk_bf16_f32 v78, v80, v81
  v_cvt_pk_bf16_f32 v79, v82, v83
  v_pk_mul_f32 v[92:93], v[92:93], v[108:109]
  v_pk_mul_f32 v[94:95], v[94:95], v[110:111]
  v_pk_mul_f32 v[96:97], v[96:97], v[112:113]
  v_pk_mul_f32 v[98:99], v[98:99], v[114:115]
  v_pk_fma_f32 v[92:93], v[124:125], v[228:229], v[92:93] op_sel:[0,1,0] op_sel_hi:[1,1,1]
  v_pk_fma_f32 v[94:95], v[126:127], v[228:229], v[94:95] op_sel:[0,1,0] op_sel_hi:[1,1,1]
  v_pk_fma_f32 v[96:97], v[128:129], v[228:229], v[96:97] op_sel:[0,1,0] op_sel_hi:[1,1,1]
  v_pk_fma_f32 v[98:99], v[130:131], v[228:229], v[98:99] op_sel:[0,1,0] op_sel_hi:[1,1,1]
  v_permlane16_swap_b32 v76, v78
  v_permlane16_swap_b32 v77, v79
  buffer_store_dwordx4 v[76:79], v231, s[20:23], s9 offen offset:2048 sc1
  ds_write_b128 v234, v[76:79] offset:6144
  v_cvt_pk_bf16_f32 v92, v92, v93
  v_cvt_pk_bf16_f32 v93, v94, v95
  v_cvt_pk_bf16_f32 v94, v96, v97
  v_cvt_pk_bf16_f32 v95, v98, v99
  s_nop 0
  v_permlane16_swap_b32 v92, v94
  v_permlane16_swap_b32 v93, v95
  buffer_store_dwordx4 v[92:95], v231, s[20:23], s9 offen offset:2304 sc1
  ds_write_b128 v234, v[92:95] offset:6400
  v_pk_mul_f32 v[4:5], v[4:5], v[204:205] op_sel:[0,0] op_sel_hi:[1,0]
  v_pk_mul_f32 v[6:7], v[6:7], v[204:205] op_sel:[0,0] op_sel_hi:[1,0]
  v_pk_mul_f32 v[8:9], v[8:9], v[204:205] op_sel:[0,0] op_sel_hi:[1,0]
  v_pk_mul_f32 v[10:11], v[10:11], v[204:205] op_sel:[0,0] op_sel_hi:[1,0]
  v_pk_fma_f32 v[4:5], v[212:213], v[204:205], v[4:5] op_sel:[0,1,0] op_sel_hi:[1,1,1]
  v_pk_fma_f32 v[6:7], v[214:215], v[204:205], v[6:7] op_sel:[0,1,0] op_sel_hi:[1,1,1]
  v_pk_fma_f32 v[8:9], v[216:217], v[204:205], v[8:9] op_sel:[0,1,0] op_sel_hi:[1,1,1]
  v_pk_fma_f32 v[10:11], v[218:219], v[204:205], v[10:11] op_sel:[0,1,0] op_sel_hi:[1,1,1]
  v_cvt_pk_bf16_f32 v4, v4, v5
  v_cvt_pk_bf16_f32 v5, v6, v7
  v_cvt_pk_bf16_f32 v6, v8, v9
  v_cvt_pk_bf16_f32 v7, v10, v11
  ds_write_b128 v233, v[4:7] offset:0
  v_pk_mul_f32 v[12:13], v[12:13], v[206:207] op_sel:[0,0] op_sel_hi:[1,0]
  v_pk_mul_f32 v[14:15], v[14:15], v[206:207] op_sel:[0,0] op_sel_hi:[1,0]
  v_pk_mul_f32 v[16:17], v[16:17], v[206:207] op_sel:[0,0] op_sel_hi:[1,0]
  v_pk_mul_f32 v[18:19], v[18:19], v[206:207] op_sel:[0,0] op_sel_hi:[1,0]
  v_pk_fma_f32 v[12:13], v[212:213], v[206:207], v[12:13] op_sel:[0,1,0] op_sel_hi:[1,1,1]
  v_pk_fma_f32 v[14:15], v[214:215], v[206:207], v[14:15] op_sel:[0,1,0] op_sel_hi:[1,1,1]
  v_pk_fma_f32 v[16:17], v[216:217], v[206:207], v[16:17] op_sel:[0,1,0] op_sel_hi:[1,1,1]
  v_pk_fma_f32 v[18:19], v[218:219], v[206:207], v[18:19] op_sel:[0,1,0] op_sel_hi:[1,1,1]
  v_cvt_pk_bf16_f32 v12, v12, v13
  v_cvt_pk_bf16_f32 v13, v14, v15
  v_cvt_pk_bf16_f32 v14, v16, v17
  v_cvt_pk_bf16_f32 v15, v18, v19
  ds_write_b128 v233, v[12:15] offset:256
  v_pk_mul_f32 v[20:21], v[20:21], v[208:209] op_sel:[0,0] op_sel_hi:[1,0]
  v_pk_mul_f32 v[22:23], v[22:23], v[208:209] op_sel:[0,0] op_sel_hi:[1,0]
  v_pk_mul_f32 v[24:25], v[24:25], v[208:209] op_sel:[0,0] op_sel_hi:[1,0]
  v_pk_mul_f32 v[26:27], v[26:27], v[208:209] op_sel:[0,0] op_sel_hi:[1,0]
  v_pk_fma_f32 v[20:21], v[212:213], v[208:209], v[20:21] op_sel:[0,1,0] op_sel_hi:[1,1,1]
  v_pk_fma_f32 v[22:23], v[214:215], v[208:209], v[22:23] op_sel:[0,1,0] op_sel_hi:[1,1,1]
  v_pk_fma_f32 v[24:25], v[216:217], v[208:209], v[24:25] op_sel:[0,1,0] op_sel_hi:[1,1,1]
  v_pk_fma_f32 v[26:27], v[218:219], v[208:209], v[26:27] op_sel:[0,1,0] op_sel_hi:[1,1,1]
  v_cvt_pk_bf16_f32 v20, v20, v21
  v_cvt_pk_bf16_f32 v21, v22, v23
  v_cvt_pk_bf16_f32 v22, v24, v25
  v_cvt_pk_bf16_f32 v23, v26, v27
  ds_write_b128 v233, v[20:23] offset:4096
  v_pk_mul_f32 v[28:29], v[28:29], v[210:211] op_sel:[0,0] op_sel_hi:[1,0]
  v_pk_mul_f32 v[30:31], v[30:31], v[210:211] op_sel:[0,0] op_sel_hi:[1,0]
  v_pk_mul_f32 v[32:33], v[32:33], v[210:211] op_sel:[0,0] op_sel_hi:[1,0]
  v_pk_mul_f32 v[34:35], v[34:35], v[210:211] op_sel:[0,0] op_sel_hi:[1,0]
  v_pk_fma_f32 v[28:29], v[212:213], v[210:211], v[28:29] op_sel:[0,1,0] op_sel_hi:[1,1,1]
  v_pk_fma_f32 v[30:31], v[214:215], v[210:211], v[30:31] op_sel:[0,1,0] op_sel_hi:[1,1,1]
  v_pk_fma_f32 v[32:33], v[216:217], v[210:211], v[32:33] op_sel:[0,1,0] op_sel_hi:[1,1,1]
  v_pk_fma_f32 v[34:35], v[218:219], v[210:211], v[34:35] op_sel:[0,1,0] op_sel_hi:[1,1,1]
  v_cvt_pk_bf16_f32 v28, v28, v29
  v_cvt_pk_bf16_f32 v29, v30, v31
  v_cvt_pk_bf16_f32 v30, v32, v33
  v_cvt_pk_bf16_f32 v31, v34, v35
  ds_write_b128 v233, v[28:31] offset:4352
  s_setprio 0
  s_waitcnt lgkmcnt(0)
  s_barrier
  s_lshl_b32 s4, s25, 13
  s_lshl_b32 s5, s24, 4
  s_add_u32 s4, s4, s5
  s_lshl_b32 s5, s3, 2
  s_add_u32 s4, s4, s5
  s_add_u32 s4, s4, 56623104
  s_waitcnt vmcnt(0)
  v_mov_b32 v184, s88
  v_lshlrev_b32 v185, 9, v2
  s_mov_b64 exec, 0xffff
  buffer_store_dword v184, v185, s[20:23], s4 offen sc1
  s_mov_b64 exec, -1
  s_branch P2_entry
P2_entry:
  s_lshr_b32 s4, s3, 2
  s_lshl_b32 s28, s25, 1
  s_add_u32 s28, s28, s4
  s_and_b32 s29, s3, 3
  s_lshl_b32 s31, s24, 2
  s_add_u32 s31, s31, s29
  s_lshl_b32 s30, s4, 14
  v_mov_b32 v120, 0x3f803f80
  v_mov_b32 v121, 0x3f803f80
  v_mov_b32 v122, 0x3f803f80
  v_mov_b32 v123, 0x3f803f80
  v_mov_b32 v60, 0
  v_mov_b32 v61, 0
  v_mov_b32 v62, 0
  v_mov_b32 v63, 0
  v_mov_b32 v64, 0
  v_mov_b32 v65, 0
  v_mov_b32 v66, 0
  v_mov_b32 v67, 0
  v_mov_b32 v68, 0
  v_mov_b32 v69, 0
  v_mov_b32 v70, 0
  v_mov_b32 v71, 0
  v_mov_b32 v72, 0
  v_mov_b32 v73, 0
  v_mov_b32 v74, 0
  v_mov_b32 v75, 0
  v_mov_b32 v76, 0
  v_mov_b32 v52, 0
  v_mov_b32 v77, 0
  v_mov_b32 v53, 0
  v_mov_b32 v78, 0
  v_mov_b32 v54, 0
  v_mov_b32 v79, 0
  v_mov_b32 v55, 0
  v_mov_b32 v80, 0
  v_mov_b32 v56, 0
  v_mov_b32 v81, 0
  v_mov_b32 v57, 0
  v_mov_b32 v82, 0
  v_mov_b32 v58, 0
  v_mov_b32 v83, 0
  v_mov_b32 v59, 0
  v_and_b32 v132, 1, v2
  v_mov_b32 v124, 0xdddddddd
  v_mul_u32_u24 v86, 0x3f80, v132
  v_lshl_or_b32 v86, v86, 16, v86
  v_mov_b32 v87, v86
  v_xor_b32 v84, 0x3f803f80, v86
  v_mov_b32 v85, v84
  v_mov_b32 v116, 0
  v_mov_b32 v117, 0
  v_mov_b32 v118, 0
  v_mov_b32 v119, 0
  v_add_u32 v126, s30, v3
  v_add_u32 v127, 32768, v126
  s_mov_b32 s59, 1
  v_lshlrev_b32 v192, 2, v2
  v_mov_b32 v125, 0
  v_mov_b32 v204, 0
  s_lshl_b32 s4, s3, 12
  s_add_u32 s4, s4, 131072
  v_add_u32 v128, s4, v3
  s_cmp_lt_u32 s3, 4
  s_cbranch_scc1 P2_a1
  s_lshl_b32 s27, s25, 13
  s_add_u32 s27, s27, 56623104
  s_lshl_b32 s62, s24, 9
  s_add_u32 s27, s27, s62
  s_mov_b64 s[98:99], 0
  s_lshr_b32 s4, s29, 1
  s_and_b32 s5, s29, 1
  s_add_u32 s100, s24, 1
  s_lshl_b32 s100, s100, 2
  s_add_u32 s100, s100, s4
  s_lshl_b32 s6, s5, 1
  s_add_u32 s100, s100, s6
  s_lshl_b32 s32, s25, 1
  s_add_u32 s32, s32, s4
  s_lshl_b32 s32, s32, 18
  s_lshl_b32 s5, s5, 13
  s_add_u32 s32, s32, s5
  s_add_u32 s32, s32, 4194304
  s_lshl_b32 s33, s29, 13
  s_add_u32 s33, s33, 32768
  s_mov_b32 s29, 0x6002
  s_barrier
P2_a1:
  ds_read_b128 v[4:7], v128 offset:2048
  ds_read_b128 v[8:11], v128 offset:3072
  ds_read_b128 v[88:91], v126 offset:0
  ds_read_b128 v[92:95], v126 offset:1024
  ds_read_b128 v[104:107], v126 offset:2048
  ds_read_b128 v[108:111], v126 offset:3072
  ds_read_b128 v[96:99], v126 offset:4096
  ds_read_b128 v[100:103], v126 offset:5120
  s_waitcnt lgkmcnt(4)
  v_mfma_f32_32x32x16_bf16 v[28:43], v[88:91], v[4:7], 0
  v_mfma_f32_32x32x16_bf16 v[28:43], v[92:95], v[8:11], v[28:43]
  s_nop 7
  s_nop 7
  v_max3_f32 v128, v28, v29, v30
  v_max3_f32 v128, v128, v31, v32
  v_max3_f32 v128, v128, v33, v34
  v_max3_f32 v128, v128, v35, v36
  v_max3_f32 v128, v128, v37, v38
  v_max3_f32 v128, v128, v39, v40
  v_max3_f32 v128, v128, v41, v42
  v_max_f32 v128, v128, v43
  v_mov_b32 v129, v128
  s_nop 1
  v_permlane32_swap_b32 v128, v129
  v_max_f32 v128, v128, v129
  v_sub_f32 v12, 0, v128
  v_sub_f32 v13, 0, v128
  v_sub_f32 v14, 0, v128
  v_sub_f32 v15, 0, v128
  v_sub_f32 v16, 0, v128
  v_sub_f32 v17, 0, v128
  v_sub_f32 v18, 0, v128
  v_sub_f32 v19, 0, v128
  v_sub_f32 v20, 0, v128
  v_sub_f32 v21, 0, v128
  v_sub_f32 v22, 0, v128
  v_sub_f32 v23, 0, v128
  v_sub_f32 v24, 0, v128
  v_sub_f32 v25, 0, v128
  v_sub_f32 v26, 0, v128
  v_sub_f32 v27, 0, v128
  s_nop 1
  v_mfma_f32_32x32x16_bf16 v[28:43], v[88:91], v[4:7], v[12:27]
  v_mfma_f32_32x32x16_bf16 v[28:43], v[92:95], v[8:11], v[28:43]
  s_nop 7
  s_nop 2
  s_waitcnt lgkmcnt(0)
  v_exp_f32 v28, v28
  v_exp_f32 v29, v29
  v_smfmac_f32_32x32x32_bf16 v[60:75], v[116:119], v[52:59], v124
  ds_read_b128 v[88:91], v126 offset:8192
  v_exp_f32 v30, v30
  v_exp_f32 v31, v31
  v_exp_f32 v32, v32
  v_smfmac_f32_16x16x64_bf16 v[80:83], v[84:87], v[52:59], v124
  ds_read_b128 v[92:95], v126 offset:9216
  v_exp_f32 v33, v33
  v_mfma_f32_32x32x16_bf16 v[44:59], v[96:99], v[4:7], v[12:27]
  ds_read_b128 v[112:115], v126 offset:6144
  v_exp_f32 v34, v34
  v_exp_f32 v35, v35
  v_exp_f32 v36, v36
  v_mfma_f32_32x32x16_bf16 v[44:59], v[100:103], v[8:11], v[44:59]
  ds_read_b128 v[116:119], v126 offset:7168
  v_exp_f32 v37, v37
  v_exp_f32 v38, v38
  v_exp_f32 v39, v39
  v_exp_f32 v40, v40
  v_smfmac_f32_32x32x32_bf16 v[60:75], v[104:107], v[28:35], v124
  s_nop 0
  v_exp_f32 v41, v41
  v_exp_f32 v42, v42
  v_exp_f32 v43, v43
  v_smfmac_f32_16x16x64_bf16 v[76:79], v[84:87], v[28:35], v124
  s_waitcnt lgkmcnt(1)
  v_exp_f32 v44, v44
  v_exp_f32 v45, v45
  v_smfmac_f32_32x32x32_bf16 v[60:75], v[108:111], v[36:43], v124
  ds_read_b128 v[96:99], v126 offset:12288
  v_exp_f32 v46, v46
  v_exp_f32 v47, v47
  v_exp_f32 v48, v48
  v_smfmac_f32_16x16x64_bf16 v[80:83], v[84:87], v[36:43], v124
  ds_read_b128 v[100:103], v126 offset:13312
  v_exp_f32 v49, v49
  v_mfma_f32_32x32x16_bf16 v[28:43], v[88:91], v[4:7], v[12:27]
  ds_read_b128 v[104:107], v126 offset:10240
  v_exp_f32 v50, v50
  v_exp_f32 v51, v51
  v_exp_f32 v52, v52
  v_mfma_f32_32x32x16_bf16 v[28:43], v[92:95], v[8:11], v[28:43]
  ds_read_b128 v[108:111], v126 offset:11264
  v_exp_f32 v53, v53
  v_exp_f32 v54, v54
  v_exp_f32 v55, v55
  v_exp_f32 v56, v56
  v_smfmac_f32_32x32x32_bf16 v[60:75], v[112:115], v[44:51], v124
  s_nop 0
  v_exp_f32 v57, v57
  v_exp_f32 v58, v58
  v_exp_f32 v59, v59
  v_smfmac_f32_16x16x64_bf16 v[76:79], v[84:87], v[44:51], v124
  s_waitcnt lgkmcnt(1)
  v_exp_f32 v28, v28
  v_exp_f32 v29, v29
  v_smfmac_f32_32x32x32_bf16 v[60:75], v[116:119], v[52:59], v124
  v_exp_f32 v30, v30
  v_exp_f32 v31, v31
  v_exp_f32 v32, v32
  v_smfmac_f32_16x16x64_bf16 v[80:83], v[84:87], v[52:59], v124
  v_exp_f32 v33, v33
  v_mfma_f32_32x32x16_bf16 v[44:59], v[96:99], v[4:7], v[12:27]
  ds_read_b128 v[112:115], v126 offset:14336
  v_exp_f32 v34, v34
  v_exp_f32 v35, v35
  v_exp_f32 v36, v36
  v_mfma_f32_32x32x16_bf16 v[44:59], v[100:103], v[8:11], v[44:59]
  ds_read_b128 v[116:119], v126 offset:15360
  v_exp_f32 v37, v37
  v_exp_f32 v38, v38
  v_exp_f32 v39, v39
  v_exp_f32 v40, v40
  v_smfmac_f32_32x32x32_bf16 v[60:75], v[104:107], v[28:35], v124
  s_nop 0
  v_exp_f32 v41, v41
  v_exp_f32 v42, v42
  v_exp_f32 v43, v43
  v_smfmac_f32_16x16x64_bf16 v[76:79], v[84:87], v[28:35], v124
  s_waitcnt lgkmcnt(1)
  v_exp_f32 v44, v44
  v_exp_f32 v45, v45
  v_smfmac_f32_32x32x32_bf16 v[60:75], v[108:111], v[36:43], v124
  v_exp_f32 v46, v46
  v_exp_f32 v47, v47
  v_exp_f32 v48, v48
  v_smfmac_f32_16x16x64_bf16 v[80:83], v[84:87], v[36:43], v124
  v_exp_f32 v49, v49
  v_exp_f32 v50, v50
  v_exp_f32 v51, v51
  v_exp_f32 v52, v52
  v_exp_f32 v53, v53
  v_exp_f32 v54, v54
  v_exp_f32 v55, v55
  v_exp_f32 v56, v56
  v_smfmac_f32_32x32x32_bf16 v[60:75], v[112:115], v[44:51], v124
  s_nop 0
  v_exp_f32 v57, v57
  v_exp_f32 v58, v58
  v_exp_f32 v59, v59
  v_smfmac_f32_16x16x64_bf16 v[76:79], v[84:87], v[44:51], v124
  s_waitcnt lgkmcnt(1)
  v_mov_b32 v126, v127
  v_add_u32 v127, 32768, v127
  v_and_b32 v127, 0x1ffff, v127
  s_cmp_lt_u32 s3, 4
  s_cbranch_scc1 P2_roleA
  s_call_b64 s[92:93], P2_issue
  s_bitcmp1_b64 s[98:99], s100
  s_cbranch_scc0 P2_b1
  s_call_b64 s[92:93], P2_issue
  s_waitcnt vmcnt(8)
  s_barrier
  s_branch P2_b2
P2_b1:
  s_waitcnt vmcnt(0)
  s_barrier
  s_call_b64 s[92:93], P2_issue
P2_b2:
  ds_read_b128 v[88:91], v126 offset:0
  ds_read_b128 v[92:95], v126 offset:1024
  ds_read_b128 v[104:107], v126 offset:2048
  ds_read_b128 v[108:111], v126 offset:3072
  ds_read_b128 v[96:99], v126 offset:4096
  ds_read_b128 v[100:103], v126 offset:5120
  s_waitcnt lgkmcnt(4)
  v_mfma_f32_32x32x16_bf16 v[28:43], v[88:91], v[4:7], v[12:27]
  v_mfma_f32_32x32x16_bf16 v[28:43], v[92:95], v[8:11], v[28:43]
  buffer_load_dword v194, v192, s[20:23], s27 offen sc1
  s_call_b64 s[92:93], P2_issue
  s_nop 7
  s_nop 2
  s_waitcnt lgkmcnt(0)
  s_setprio 1
P2_loopB:
  v_exp_f32 v28, v28
  v_exp_f32 v29, v29
  v_smfmac_f32_32x32x32_bf16 v[60:75], v[116:119], v[52:59], v124
  ds_read_b128 v[88:91], v126 offset:8192
  v_exp_f32 v30, v30
  v_exp_f32 v31, v31
  v_exp_f32 v32, v32
  v_smfmac_f32_16x16x64_bf16 v[80:83], v[84:87], v[52:59], v124
  ds_read_b128 v[92:95], v126 offset:9216
  v_exp_f32 v33, v33
  v_mfma_f32_32x32x16_bf16 v[44:59], v[96:99], v[4:7], v[12:27]
  ds_read_b128 v[112:115], v126 offset:6144
  v_exp_f32 v34, v34
  v_exp_f32 v35, v35
  v_exp_f32 v36, v36
  v_mfma_f32_32x32x16_bf16 v[44:59], v[100:103], v[8:11], v[44:59]
  ds_read_b128 v[116:119], v126 offset:7168
  v_exp_f32 v37, v37
  v_exp_f32 v38, v38
  v_exp_f32 v39, v39
  v_exp_f32 v40, v40
  v_smfmac_f32_32x32x32_bf16 v[60:75], v[104:107], v[28:35], v124
  s_nop 0
  v_exp_f32 v41, v41
  v_exp_f32 v42, v42
  v_exp_f32 v43, v43
  v_smfmac_f32_16x16x64_bf16 v[76:79], v[84:87], v[28:35], v124
  s_waitcnt lgkmcnt(1)
  v_exp_f32 v44, v44
  v_exp_f32 v45, v45
  v_smfmac_f32_32x32x32_bf16 v[60:75], v[108:111], v[36:43], v124
  ds_read_b128 v[96:99], v126 offset:12288
  v_exp_f32 v46, v46
  v_exp_f32 v47, v47
  v_exp_f32 v48, v48
  v_smfmac_f32_16x16x64_bf16 v[80:83], v[84:87], v[36:43], v124
  ds_read_b128 v[100:103], v126 offset:13312
  v_exp_f32 v49, v49
  v_mfma_f32_32x32x16_bf16 v[28:43], v[88:91], v[4:7], v[12:27]
  ds_read_b128 v[104:107], v126 offset:10240
  v_exp_f32 v50, v50
  v_exp_f32 v51, v51
  v_exp_f32 v52, v52
  v_mfma_f32_32x32x16_bf16 v[28:43], v[92:95], v[8:11], v[28:43]
  ds_read_b128 v[108:111], v126 offset:11264
  v_exp_f32 v53, v53
  v_exp_f32 v54, v54
  v_exp_f32 v55, v55
  v_exp_f32 v56, v56
  v_smfmac_f32_32x32x32_bf16 v[60:75], v[112:115], v[44:51], v124
  s_nop 0
  v_exp_f32 v57, v57
  v_exp_f32 v58, v58
  v_exp_f32 v59, v59
  s_bitcmp1_b32 s29, s59
  v_smfmac_f32_16x16x64_bf16 v[76:79], v[84:87], v[44:51], v124
  s_waitcnt lgkmcnt(1)
  s_cbranch_scc1 P2_MB
  s_waitcnt vmcnt(8)
  s_barrier
P2_contB:
  s_bitcmp1_b64 s[98:99], s100
  s_cbranch_scc0 P2_needX
P2_contB2:
  v_exp_f32 v28, v28
  s_lshl_b32 s101, s100, 12
  s_and_b32 s101, s101, 0x3c000
  s_add_u32 s101, s101, s32
  s_add_u32 s100, s100, 4
  s_mov_b32 m0, s33
  s_add_u32 s33, s33, 32768
  s_and_b32 s33, s33, 0x1ffff
  v_exp_f32 v29, v29
  v_smfmac_f32_32x32x32_bf16 v[60:75], v[116:119], v[52:59], v124
  ds_read_b128 v[88:91], v127 offset:0
  v_exp_f32 v30, v30
  buffer_load_dwordx4 v3, s[20:23], s101 offen offset:0 lds
  v_exp_f32 v31, v31
  v_exp_f32 v32, v32
  v_smfmac_f32_16x16x64_bf16 v[80:83], v[84:87], v[52:59], v124
  ds_read_b128 v[92:95], v127 offset:1024
  v_exp_f32 v33, v33
  v_mfma_f32_32x32x16_bf16 v[44:59], v[96:99], v[4:7], v[12:27]
  ds_read_b128 v[112:115], v126 offset:14336
  v_exp_f32 v34, v34
  buffer_load_dwordx4 v3, s[20:23], s101 offen offset:1024 lds
  v_exp_f32 v35, v35
  v_exp_f32 v36, v36
  v_mfma_f32_32x32x16_bf16 v[44:59], v[100:103], v[8:11], v[44:59]
  ds_read_b128 v[116:119], v126 offset:15360
  v_exp_f32 v37, v37
  buffer_load_dwordx4 v3, s[20:23], s101 offen offset:2048 lds
  v_exp_f32 v38, v38
  v_exp_f32 v39, v39
  v_exp_f32 v40, v40
  v_smfmac_f32_32x32x32_bf16 v[60:75], v[104:107], v[28:35], v124
  buffer_load_dwordx4 v3, s[20:23], s101 offen offset:3072 lds
  v_exp_f32 v41, v41
  v_exp_f32 v42, v42
  s_add_u32 m0, m0, 4096
  s_add_u32 s101, s101, 4096
  v_exp_f32 v43, v43
  v_smfmac_f32_16x16x64_bf16 v[76:79], v[84:87], v[28:35], v124
  s_waitcnt lgkmcnt(1)
  v_exp_f32 v44, v44
  v_exp_f32 v45, v45
  v_smfmac_f32_32x32x32_bf16 v[60:75], v[108:111], v[36:43], v124
  ds_read_b128 v[96:99], v127 offset:4096
  v_exp_f32 v46, v46
  buffer_load_dwordx4 v3, s[20:23], s101 offen offset:0 lds
  v_exp_f32 v47, v47
  v_exp_f32 v48, v48
  v_smfmac_f32_16x16x64_bf16 v[80:83], v[84:87], v[36:43], v124
  ds_read_b128 v[100:103], v127 offset:5120
  v_exp_f32 v49, v49
  v_mfma_f32_32x32x16_bf16 v[28:43], v[88:91], v[4:7], v[12:27]
  ds_read_b128 v[104:107], v127 offset:2048
  v_exp_f32 v50, v50
  buffer_load_dwordx4 v3, s[20:23], s101 offen offset:1024 lds
  v_exp_f32 v51, v51
  v_exp_f32 v52, v52
  v_mfma_f32_32x32x16_bf16 v[28:43], v[92:95], v[8:11], v[28:43]
  ds_read_b128 v[108:111], v127 offset:3072
  v_exp_f32 v53, v53
  buffer_load_dwordx4 v3, s[20:23], s101 offen offset:2048 lds
  v_exp_f32 v54, v54
  v_exp_f32 v55, v55
  v_exp_f32 v56, v56
  v_smfmac_f32_32x32x32_bf16 v[60:75], v[112:115], v[44:51], v124
  buffer_load_dwordx4 v3, s[20:23], s101 offen offset:3072 lds
  v_exp_f32 v57, v57
  v_exp_f32 v58, v58
  s_add_u32 s59, s59, 1
  v_exp_f32 v59, v59
  s_cmp_lg_u32 s59, 16
  v_smfmac_f32_16x16x64_bf16 v[76:79], v[84:87], v[44:51], v124
  s_waitcnt lgkmcnt(1)
  v_mov_b32 v126, v127
  v_add_u32 v127, 32768, v127
  v_and_b32 v127, 0x1ffff, v127
  s_cbranch_scc1 P2_loopB
P2_endB:
  s_cmp_lg_u32 s3, 7
  s_cbranch_scc1 P2_fin
  s_waitcnt vmcnt(0)
  s_mov_b32 s4, 55969280
  s_mov_b32 s91, 200000
  v_cmp_ne_u32 vcc, s88, v120
  v_cmp_ne_u32 s[62:63], s88, v121
  s_nop 0
  s_or_b64 vcc, vcc, s[62:63]
  s_cbranch_vccz POK_5
PTOP_6:
  buffer_load_dwordx2 v[120:121], v128, s[20:23], s4 offen sc1
  s_waitcnt vmcnt(0)
  v_cmp_ne_u32 vcc, s88, v120
  v_cmp_ne_u32 s[62:63], s88, v121
  s_nop 0
  s_or_b64 vcc, vcc, s[62:63]
  s_cbranch_vccz POK_5
  s_sleep 4
  s_sub_u32 s91, s91, 1
  s_cmp_lg_u32 s91, 0
  s_cbranch_scc1 PTOP_6
POK_5:
  s_branch P2_fin
P2_MB:
  s_waitcnt vmcnt(8)
  s_barrier
  s_cmp_eq_u32 s59, 13
  s_cbranch_scc1 P2_MB13
  s_cmp_eq_u32 s59, 14
  s_cbranch_scc1 P2_MB14
  v_cmp_eq_u32 s[62:63], s88, v194
  s_nop 1
  s_or_b64 s[98:99], s[98:99], s[62:63]
  s_branch P2_contB
P2_MB13:
  s_mov_b32 s32, 0x10000000
  s_mov_b64 s[98:99], -1
  s_branch P2_contB
P2_MB14:
  s_cmp_lg_u32 s3, 7
  s_cbranch_scc1 P2_contB
  s_mov_b32 s4, 55969280
  v_lshlrev_b32 v128, 3, v2
  buffer_load_dwordx2 v[120:121], v128, s[20:23], s4 offen sc1
  s_branch P2_contB
P2_needX:
  s_call_b64 s[24:25], P2_need2
  s_branch P2_contB2
P2_issue:
  s_bitcmp1_b64 s[98:99], s100
  s_cbranch_scc1 P2_issue_1
  s_call_b64 s[24:25], P2_need2
P2_issue_1:
  s_lshl_b32 s101, s100, 12
  s_and_b32 s101, s101, 0x3c000
  s_add_u32 s101, s101, s32
  s_add_u32 s100, s100, 4
  s_mov_b32 m0, s33
  s_add_u32 s33, s33, 32768
  s_and_b32 s33, s33, 0x1ffff
  buffer_load_dwordx4 v3, s[20:23], s101 offen offset:0 lds
  buffer_load_dwordx4 v3, s[20:23], s101 offen offset:1024 lds
  buffer_load_dwordx4 v3, s[20:23], s101 offen offset:2048 lds
  buffer_load_dwordx4 v3, s[20:23], s101 offen offset:3072 lds
  s_add_u32 m0, m0, 4096
  s_add_u32 s101, s101, 4096
  buffer_load_dwordx4 v3, s[20:23], s101 offen offset:0 lds
  buffer_load_dwordx4 v3, s[20:23], s101 offen offset:1024 lds
  buffer_load_dwordx4 v3, s[20:23], s101 offen offset:2048 lds
  buffer_load_dwordx4 v3, s[20:23], s101 offen offset:3072 lds
  s_setpc_b64 s[92:93]
P2_issue4:
  s_bitcmp1_b64 s[98:99], s100
  s_cbranch_scc1 P2_issue4_1
  s_call_b64 s[24:25], P2_need2
P2_issue4_1:
  s_lshl_b32 s101, s100, 12
  s_and_b32 s101, s101, 0x3c000
  s_add_u32 s101, s101, s32
  s_add_u32 s100, s100, 4
  s_mov_b32 m0, s33
  s_add_u32 s33, s33, 32768
  s_and_b32 s33, s33, 0x1ffff
  buffer_load_dwordx4 v3, s[20:23], s101 offen offset:0 lds
  buffer_load_dwordx4 v3, s[20:23], s101 offen offset:1024 lds
  buffer_load_dwordx4 v3, s[20:23], s101 offen offset:2048 lds
  buffer_load_dwordx4 v3, s[20:23], s101 offen offset:3072 lds
  s_add_u32 m0, m0, 4096
  s_add_u32 s101, s101, 4096
  s_setpc_b64 s[92:93]
P2_need2:
  s_mov_b32 s91, 200000
P2_need2_t:
  buffer_load_dword v193, v192, s[20:23], s27 offen sc1
  s_waitcnt vmcnt(0)
  v_cmp_eq_u32 s[98:99], s88, v193
  s_nop 1
  s_bitcmp1_b64 s[98:99], s100
  s_cbranch_scc1 P2_need2_r
  s_sleep 4
  s_sub_u32 s91, s91, 1
  s_cmp_lg_u32 s91, 0
  s_cbranch_scc1 P2_need2_t
P2_need2_r:
  s_setpc_b64 s[24:25]
P2_roleA:
  s_lshl_b32 s4, s2, 2
  s_add_u32 s4, s4, s3
  s_lshl_b32 s94, s4, 2
  s_add_u32 s94, s94, 55969280
  s_lshr_b32 s5, s4, 3
  s_and_b32 s6, s4, 7
  s_mov_b32 s7, 2048
  s_mov_b32 s8, 35651584
  s_mov_b32 s9, 64
  s_mov_b32 s10, 0
  s_mov_b32 s16, s40
  s_mov_b32 s17, s41
  s_mov_b32 s18, 0x200000
  s_mov_b32 s19, 0x20000
  s_cmp_lt_u32 s4, 128
  s_cbranch_scc1 P2_dec
  s_cmp_lt_u32 s4, 576
  s_cbranch_scc1 P2_dec1
  s_sub_u32 s4, s4, 576
  s_lshr_b32 s5, s4, 3
  s_and_b32 s6, s4, 7
  s_mov_b32 s8, 45088768
  s_mov_b32 s9, 224
  s_mov_b32 s10, 2
  s_mov_b32 s16, s48
  s_mov_b32 s17, s49
  s_mov_b32 s18, 0x700000
  s_mov_b32 s19, 0x20000
  s_branch P2_dec
P2_dec1:
  s_sub_u32 s4, s4, 128
  s_mul_i32 s5, s4, 2341
  s_lshr_b32 s5, s5, 16
  s_mul_i32 s6, s5, 28
  s_sub_u32 s6, s4, s6
  s_mov_b32 s7, 7168
  s_mov_b32 s8, 37748736
  s_mov_b32 s10, 1
  s_mov_b32 s16, s44
  s_mov_b32 s17, s45
  s_mov_b32 s18, 0x700000
  s_mov_b32 s19, 0x20000
P2_dec:
  v_lshrrev_b32 v132, 3, v2
  v_mul_lo_u32 v132, v132, s7
  v_bfe_u32 v130, v2, 4, 1
  v_lshlrev_b32 v130, 2, v130
  v_and_b32 v131, 7, v2
  v_xor_b32 v130, v130, v131
  v_lshl_add_u32 v125, v130, 4, v132
  s_lshl_b32 s11, s5, 6
  s_mul_i32 s11, s11, s7
  s_lshl_b32 s35, s6, 8
  s_add_u32 s11, s11, s35
  s_lshl_b32 s35, s7, 3
  s_lshl_b32 s58, s3, 13
  s_add_u32 s58, s58, 131072
  s_cmp_eq_u32 s10, 0
  s_cselect_b32 s4, 2, 4
  s_cselect_b32 s15, 2, 1
  s_lshl_b32 s15, s15, 9
  v_lshrrev_b32 v134, 5, v2
  v_lshlrev_b32 v134, s4, v134
  v_bfe_u32 v135, v2, 2, 2
  v_add_u32 v134, v134, v135
  v_lshlrev_b32 v134, 7, v134
  v_lshrrev_b32 v135, 1, v135
  v_lshl_add_u32 v134, v135, 6, v134
  v_and_b32 v135, 1, v2
  v_lshl_add_u32 v134, v135, 5, v134
  v_bfe_u32 v135, v2, 4, 1
  v_lshl_add_u32 v134, v135, 4, v134
  v_bfe_u32 v135, v2, 1, 1
  v_lshl_add_u32 v134, v135, 3, v134
  v_add_u32 v196, s58, v134
  v_add_u32 v197, s15, v196
  v_add_u32 v198, s15, v197
  v_add_u32 v199, s15, v198
  v_xor_b32 v200, 64, v196
  v_xor_b32 v201, 64, v197
  v_xor_b32 v202, 64, v198
  v_xor_b32 v203, 64, v199
  s_lshl_b32 s12, s6, 2
  s_mul_i32 s12, s12, s9
  s_lshl_b32 s4, s5, 2
  s_add_u32 s12, s12, s4
  s_lshl_b32 s12, s12, 10
  s_add_u32 s12, s12, s8
  s_lshl_b32 s13, s9, 10
  s_mul_i32 s14, s5, 28672
  s_lshl_b32 s4, s6, 9
  s_add_u32 s14, s14, s4
  s_add_u32 s14, s14, 52428800
  v_bfe_u32 v134, v2, 2, 1
  v_lshlrev_b32 v134, 4, v134
  v_bfe_u32 v135, v2, 3, 2
  v_lshl_add_u32 v134, v135, 2, v134
  v_and_b32 v135, 0x23, v2
  v_add_u32 v134, v134, v135
  v_lshlrev_b32 v204, 2, v134
  s_bfe_u32 s26, s2, 0x20005
  s_lshl_b32 s29, 0x532, s26
  s_add_u32 s26, s26, 1
  s_add_u32 s6, s26, 4
  s_add_u32 s7, s26, 9
  s_barrier
  ds_read_b128 v[88:91], v126 offset:0
  ds_read_b128 v[92:95], v126 offset:1024
  ds_read_b128 v[104:107], v126 offset:2048
  ds_read_b128 v[108:111], v126 offset:3072
  ds_read_b128 v[96:99], v126 offset:4096
  ds_read_b128 v[100:103], v126 offset:5120
  s_waitcnt lgkmcnt(4)
  v_mfma_f32_32x32x16_bf16 v[28:43], v[88:91], v[4:7], v[12:27]
  v_mfma_f32_32x32x16_bf16 v[28:43], v[92:95], v[8:11], v[28:43]
  s_nop 7
  s_nop 2
  s_waitcnt lgkmcnt(0)
P2_loopA:
  v_exp_f32 v28, v28
  v_exp_f32 v29, v29
  v_smfmac_f32_32x32x32_bf16 v[60:75], v[116:119], v[52:59], v124
  ds_read_b128 v[88:91], v126 offset:8192
  v_exp_f32 v30, v30
  v_exp_f32 v31, v31
  v_exp_f32 v32, v32
  v_smfmac_f32_16x16x64_bf16 v[80:83], v[84:87], v[52:59], v124
  ds_read_b128 v[92:95], v126 offset:9216
  v_exp_f32 v33, v33
  v_mfma_f32_32x32x16_bf16 v[44:59], v[96:99], v[4:7], v[12:27]
  ds_read_b128 v[112:115], v126 offset:6144
  v_exp_f32 v34, v34
  v_exp_f32 v35, v35
  v_exp_f32 v36, v36
  v_mfma_f32_32x32x16_bf16 v[44:59], v[100:103], v[8:11], v[44:59]
  ds_read_b128 v[116:119], v126 offset:7168
  v_exp_f32 v37, v37
  v_exp_f32 v38, v38
  v_exp_f32 v39, v39
  v_exp_f32 v40, v40
  v_smfmac_f32_32x32x32_bf16 v[60:75], v[104:107], v[28:35], v124
  s_nop 0
  v_exp_f32 v41, v41
  v_exp_f32 v42, v42
  v_exp_f32 v43, v43
  v_smfmac_f32_16x16x64_bf16 v[76:79], v[84:87], v[28:35], v124
  s_waitcnt lgkmcnt(1)
  v_exp_f32 v44, v44
  v_exp_f32 v45, v45
  v_smfmac_f32_32x32x32_bf16 v[60:75], v[108:111], v[36:43], v124
  ds_read_b128 v[96:99], v126 offset:12288
  v_exp_f32 v46, v46
  v_exp_f32 v47, v47
  v_exp_f32 v48, v48
  v_smfmac_f32_16x16x64_bf16 v[80:83], v[84:87], v[36:43], v124
  ds_read_b128 v[100:103], v126 offset:13312
  v_exp_f32 v49, v49
  v_mfma_f32_32x32x16_bf16 v[28:43], v[88:91], v[4:7], v[12:27]
  ds_read_b128 v[104:107], v126 offset:10240
  v_exp_f32 v50, v50
  v_exp_f32 v51, v51
  v_exp_f32 v52, v52
  v_mfma_f32_32x32x16_bf16 v[28:43], v[92:95], v[8:11], v[28:43]
  ds_read_b128 v[108:111], v126 offset:11264
  v_exp_f32 v53, v53
  v_exp_f32 v54, v54
  v_exp_f32 v55, v55
  v_exp_f32 v56, v56
  v_smfmac_f32_32x32x32_bf16 v[60:75], v[112:115], v[44:51], v124
  s_nop 0
  v_exp_f32 v57, v57
  v_exp_f32 v58, v58
  v_exp_f32 v59, v59
  s_bitcmp1_b32 s29, s59
  v_smfmac_f32_16x16x64_bf16 v[76:79], v[84:87], v[44:51], v124
  s_waitcnt lgkmcnt(1)
P2_barA:
  s_barrier
  s_cbranch_scc1 P2_MA
P2_contA:
  v_exp_f32 v28, v28
  v_exp_f32 v29, v29
  v_smfmac_f32_32x32x32_bf16 v[60:75], v[116:119], v[52:59], v124
  ds_read_b128 v[88:91], v127 offset:0
  v_exp_f32 v30, v30
  v_exp_f32 v31, v31
  v_exp_f32 v32, v32
  v_smfmac_f32_16x16x64_bf16 v[80:83], v[84:87], v[52:59], v124
  ds_read_b128 v[92:95], v127 offset:1024
  v_exp_f32 v33, v33
  v_mfma_f32_32x32x16_bf16 v[44:59], v[96:99], v[4:7], v[12:27]
  ds_read_b128 v[112:115], v126 offset:14336
  v_exp_f32 v34, v34
  v_exp_f32 v35, v35
  v_exp_f32 v36, v36
  v_mfma_f32_32x32x16_bf16 v[44:59], v[100:103], v[8:11], v[44:59]
  ds_read_b128 v[116:119], v126 offset:15360
  v_exp_f32 v37, v37
  v_exp_f32 v38, v38
  v_exp_f32 v39, v39
  v_exp_f32 v40, v40
  v_smfmac_f32_32x32x32_bf16 v[60:75], v[104:107], v[28:35], v124
  s_nop 0
  v_exp_f32 v41, v41
  v_exp_f32 v42, v42
  v_exp_f32 v43, v43
  v_smfmac_f32_16x16x64_bf16 v[76:79], v[84:87], v[28:35], v124
  s_waitcnt lgkmcnt(1)
  v_exp_f32 v44, v44
  v_exp_f32 v45, v45
  v_smfmac_f32_32x32x32_bf16 v[60:75], v[108:111], v[36:43], v124
  ds_read_b128 v[96:99], v127 offset:4096
  v_exp_f32 v46, v46
  v_exp_f32 v47, v47
  v_exp_f32 v48, v48
  v_smfmac_f32_16x16x64_bf16 v[80:83], v[84:87], v[36:43], v124
  ds_read_b128 v[100:103], v127 offset:5120
  v_exp_f32 v49, v49
  v_mfma_f32_32x32x16_bf16 v[28:43], v[88:91], v[4:7], v[12:27]
  ds_read_b128 v[104:107], v127 offset:2048
  v_exp_f32 v50, v50
  v_exp_f32 v51, v51
  v_exp_f32 v52, v52
  v_mfma_f32_32x32x16_bf16 v[28:43], v[92:95], v[8:11], v[28:43]
  ds_read_b128 v[108:111], v127 offset:3072
  v_exp_f32 v53, v53
  v_exp_f32 v54, v54
  v_exp_f32 v55, v55
  v_exp_f32 v56, v56
  v_smfmac_f32_32x32x32_bf16 v[60:75], v[112:115], v[44:51], v124
  s_nop 0
  v_exp_f32 v57, v57
  s_add_u32 s59, s59, 1
  v_exp_f32 v58, v58
  s_cmp_lg_u32 s59, 16
  v_exp_f32 v59, v59
  v_smfmac_f32_16x16x64_bf16 v[76:79], v[84:87], v[44:51], v124
  s_waitcnt lgkmcnt(1)
  v_mov_b32 v126, v127
  v_add_u32 v127, 32768, v127
  v_and_b32 v127, 0x1ffff, v127
  s_cbranch_scc1 P2_loopA
  s_branch P2_fin
P2_MA:
  s_cmp_eq_u32 s59, s26
  s_cbranch_scc1 P2_specL
  s_cmp_eq_u32 s59, s6
  s_cbranch_scc1 P2_specL
  s_waitcnt vmcnt(0)
  s_cmp_eq_u32 s59, s7
  s_cbranch_scc1 P2_MA3
  ds_read_b64_tr_b16 v[128:129], v196 offset:0
  ds_read_b64_tr_b16 v[130:131], v197 offset:0
  ds_read_b64_tr_b16 v[132:133], v198 offset:0
  ds_read_b64_tr_b16 v[134:135], v199 offset:0
  ds_read_b64_tr_b16 v[136:137], v200 offset:0
  ds_read_b64_tr_b16 v[138:139], v201 offset:0
  ds_read_b64_tr_b16 v[140:141], v202 offset:0
  ds_read_b64_tr_b16 v[142:143], v203 offset:0
  ds_read_b64_tr_b16 v[144:145], v196 offset:4096
  ds_read_b64_tr_b16 v[146:147], v197 offset:4096
  ds_read_b64_tr_b16 v[148:149], v198 offset:4096
  ds_read_b64_tr_b16 v[150:151], v199 offset:4096
  ds_read_b64_tr_b16 v[152:153], v200 offset:4096
  ds_read_b64_tr_b16 v[154:155], v201 offset:4096
  ds_read_b64_tr_b16 v[156:157], v202 offset:4096
  ds_read_b64_tr_b16 v[158:159], v203 offset:4096
  s_mov_b32 s4, s12
  s_add_u32 s12, s12, 2048
  v_cmp_lt_u32 vcc, 31, v2
  s_cmp_eq_u32 s10, 1
  s_waitcnt lgkmcnt(0)
  s_cbranch_scc1 P2_specC
  v_exp_f32 v28, v28
  v_exp_f32 v29, v29
  v_smfmac_f32_32x32x32_bf16 v[60:75], v[116:119], v[52:59], v124
  ds_read_b128 v[88:91], v127 offset:0
  v_exp_f32 v30, v30
  v_exp_f32 v31, v31
  buffer_store_dwordx4 v[128:131], v3, s[20:23], s4 offen sc1
  v_exp_f32 v32, v32
  v_smfmac_f32_16x16x64_bf16 v[80:83], v[84:87], v[52:59], v124
  ds_read_b128 v[92:95], v127 offset:1024
  v_exp_f32 v33, v33
  v_mfma_f32_32x32x16_bf16 v[44:59], v[96:99], v[4:7], v[12:27]
  ds_read_b128 v[112:115], v126 offset:14336
  v_exp_f32 v34, v34
  v_exp_f32 v35, v35
  v_exp_f32 v36, v36
  v_mfma_f32_32x32x16_bf16 v[44:59], v[100:103], v[8:11], v[44:59]
  ds_read_b128 v[116:119], v126 offset:15360
  v_exp_f32 v37, v37
  v_exp_f32 v38, v38
  buffer_store_dwordx4 v[132:135], v3, s[20:23], s4 offen offset:1024 sc1
  s_add_u32 s4, s4, s13
  v_exp_f32 v39, v39
  v_exp_f32 v40, v40
  v_smfmac_f32_32x32x32_bf16 v[60:75], v[104:107], v[28:35], v124
  s_nop 0
  v_exp_f32 v41, v41
  v_exp_f32 v42, v42
  v_exp_f32 v43, v43
  v_smfmac_f32_16x16x64_bf16 v[76:79], v[84:87], v[28:35], v124
  s_waitcnt lgkmcnt(1)
  v_exp_f32 v44, v44
  v_exp_f32 v45, v45
  v_smfmac_f32_32x32x32_bf16 v[60:75], v[108:111], v[36:43], v124
  ds_read_b128 v[96:99], v127 offset:4096
  v_exp_f32 v46, v46
  v_exp_f32 v47, v47
  buffer_store_dwordx4 v[136:139], v3, s[20:23], s4 offen sc1
  v_exp_f32 v48, v48
  v_smfmac_f32_16x16x64_bf16 v[80:83], v[84:87], v[36:43], v124
  ds_read_b128 v[100:103], v127 offset:5120
  v_exp_f32 v49, v49
  v_mfma_f32_32x32x16_bf16 v[28:43], v[88:91], v[4:7], v[12:27]
  ds_read_b128 v[104:107], v127 offset:2048
  v_exp_f32 v50, v50
  v_exp_f32 v51, v51
  v_exp_f32 v52, v52
  v_mfma_f32_32x32x16_bf16 v[28:43], v[92:95], v[8:11], v[28:43]
  ds_read_b128 v[108:111], v127 offset:3072
  v_exp_f32 v53, v53
  v_exp_f32 v54, v54
  buffer_store_dwordx4 v[140:143], v3, s[20:23], s4 offen offset:1024 sc1
  s_add_u32 s4, s4, s13
  v_exp_f32 v55, v55
  v_exp_f32 v56, v56
  v_smfmac_f32_32x32x32_bf16 v[60:75], v[112:115], v[44:51], v124
  s_nop 0
  v_exp_f32 v57, v57
  v_exp_f32 v58, v58
  s_add_u32 s59, s59, 1
  v_exp_f32 v59, v59
  v_smfmac_f32_16x16x64_bf16 v[76:79], v[84:87], v[44:51], v124
  s_waitcnt lgkmcnt(1)
  v_mov_b32 v126, v127
  v_add_u32 v127, 32768, v127
  v_and_b32 v127, 0x1ffff, v127
  v_exp_f32 v28, v28
  v_exp_f32 v29, v29
  v_smfmac_f32_32x32x32_bf16 v[60:75], v[116:119], v[52:59], v124
  ds_read_b128 v[88:91], v126 offset:8192
  v_exp_f32 v30, v30
  v_exp_f32 v31, v31
  buffer_store_dwordx4 v[144:147], v3, s[20:23], s4 offen sc1
  v_exp_f32 v32, v32
  v_smfmac_f32_16x16x64_bf16 v[80:83], v[84:87], v[52:59], v124
  ds_read_b128 v[92:95], v126 offset:9216
  v_exp_f32 v33, v33
  v_mfma_f32_32x32x16_bf16 v[44:59], v[96:99], v[4:7], v[12:27]
  ds_read_b128 v[112:115], v126 offset:6144
  v_exp_f32 v34, v34
  v_exp_f32 v35, v35
  v_exp_f32 v36, v36
  v_mfma_f32_32x32x16_bf16 v[44:59], v[100:103], v[8:11], v[44:59]
  ds_read_b128 v[116:119], v126 offset:7168
  v_exp_f32 v37, v37
  v_exp_f32 v38, v38
  buffer_store_dwordx4 v[148:151], v3, s[20:23], s4 offen offset:1024 sc1
  s_add_u32 s4, s4, s13
  v_exp_f32 v39, v39
  v_exp_f32 v40, v40
  v_smfmac_f32_32x32x32_bf16 v[60:75], v[104:107], v[28:35], v124
  s_nop 0
  v_exp_f32 v41, v41
  v_exp_f32 v42, v42
  v_exp_f32 v43, v43
  v_smfmac_f32_16x16x64_bf16 v[76:79], v[84:87], v[28:35], v124
  s_waitcnt lgkmcnt(1)
  v_exp_f32 v44, v44
  v_exp_f32 v45, v45
  v_smfmac_f32_32x32x32_bf16 v[60:75], v[108:111], v[36:43], v124
  ds_read_b128 v[96:99], v126 offset:12288
  v_exp_f32 v46, v46
  v_exp_f32 v47, v47
  buffer_store_dwordx4 v[152:155], v3, s[20:23], s4 offen sc1
  v_exp_f32 v48, v48
  v_smfmac_f32_16x16x64_bf16 v[80:83], v[84:87], v[36:43], v124
  ds_read_b128 v[100:103], v126 offset:13312
  v_exp_f32 v49, v49
  v_mfma_f32_32x32x16_bf16 v[28:43], v[88:91], v[4:7], v[12:27]
  ds_read_b128 v[104:107], v126 offset:10240
  v_exp_f32 v50, v50
  v_exp_f32 v51, v51
  v_exp_f32 v52, v52
  v_mfma_f32_32x32x16_bf16 v[28:43], v[92:95], v[8:11], v[28:43]
  ds_read_b128 v[108:111], v126 offset:11264
  v_exp_f32 v53, v53
  v_exp_f32 v54, v54
  buffer_store_dwordx4 v[156:159], v3, s[20:23], s4 offen offset:1024 sc1
  s_add_u32 s4, s4, s13
  v_exp_f32 v55, v55
  v_exp_f32 v56, v56
  v_smfmac_f32_32x32x32_bf16 v[60:75], v[112:115], v[44:51], v124
  s_nop 0
  v_exp_f32 v57, v57
  v_exp_f32 v58, v58
  v_exp_f32 v59, v59
  s_bitcmp1_b32 s29, s59
  v_smfmac_f32_16x16x64_bf16 v[76:79], v[84:87], v[44:51], v124
  s_waitcnt lgkmcnt(1)
  s_branch P2_barA
P2_specC:
  v_exp_f32 v28, v28
  v_exp_f32 v29, v29
  v_mfma_f32_32x32x16_bf16 v[160:175], v[120:123], v[128:131], 0
  v_smfmac_f32_32x32x32_bf16 v[60:75], v[116:119], v[52:59], v124
  ds_read_b128 v[88:91], v127 offset:0
  v_exp_f32 v30, v30
  v_exp_f32 v31, v31
  buffer_store_dwordx4 v[128:131], v3, s[20:23], s4 offen sc1
  v_exp_f32 v32, v32
  v_smfmac_f32_16x16x64_bf16 v[80:83], v[84:87], v[52:59], v124
  ds_read_b128 v[92:95], v127 offset:1024
  v_exp_f32 v33, v33
  v_mfma_f32_32x32x16_bf16 v[44:59], v[96:99], v[4:7], v[12:27]
  ds_read_b128 v[112:115], v126 offset:14336
  v_exp_f32 v34, v34
  v_mfma_f32_32x32x16_bf16 v[160:175], v[120:123], v[132:135], v[160:175]
  v_exp_f32 v35, v35
  v_exp_f32 v36, v36
  v_mfma_f32_32x32x16_bf16 v[44:59], v[100:103], v[8:11], v[44:59]
  ds_read_b128 v[116:119], v126 offset:15360
  v_exp_f32 v37, v37
  v_exp_f32 v38, v38
  buffer_store_dwordx4 v[132:135], v3, s[20:23], s4 offen offset:1024 sc1
  s_add_u32 s4, s4, s13
  v_exp_f32 v39, v39
  v_exp_f32 v40, v40
  v_mfma_f32_32x32x16_bf16 v[176:191], v[120:123], v[136:139], 0
  v_smfmac_f32_32x32x32_bf16 v[60:75], v[104:107], v[28:35], v124
  s_nop 0
  v_exp_f32 v41, v41
  v_exp_f32 v42, v42
  v_exp_f32 v43, v43
  v_mfma_f32_32x32x16_bf16 v[176:191], v[120:123], v[140:143], v[176:191]
  v_smfmac_f32_16x16x64_bf16 v[76:79], v[84:87], v[28:35], v124
  s_waitcnt lgkmcnt(1)
  v_exp_f32 v44, v44
  v_exp_f32 v45, v45
  v_smfmac_f32_32x32x32_bf16 v[60:75], v[108:111], v[36:43], v124
  ds_read_b128 v[96:99], v127 offset:4096
  v_exp_f32 v46, v46
  v_exp_f32 v47, v47
  buffer_store_dwordx4 v[136:139], v3, s[20:23], s4 offen sc1
  v_exp_f32 v48, v48
  v_smfmac_f32_16x16x64_bf16 v[80:83], v[84:87], v[36:43], v124
  ds_read_b128 v[100:103], v127 offset:5120
  v_exp_f32 v49, v49
  v_mfma_f32_32x32x16_bf16 v[28:43], v[88:91], v[4:7], v[12:27]
  ds_read_b128 v[104:107], v127 offset:2048
  v_exp_f32 v50, v50
  v_exp_f32 v51, v51
  v_exp_f32 v52, v52
  v_mfma_f32_32x32x16_bf16 v[28:43], v[92:95], v[8:11], v[28:43]
  ds_read_b128 v[108:111], v127 offset:3072
  v_exp_f32 v53, v53
  v_exp_f32 v54, v54
  buffer_store_dwordx4 v[140:143], v3, s[20:23], s4 offen offset:1024 sc1
  s_add_u32 s4, s4, s13
  v_exp_f32 v55, v55
  v_exp_f32 v56, v56
  v_cndmask_b32 v193, v160, v176, vcc
  buffer_store_dword v193, v204, s[20:23], s14 offen offset:0 sc1
  v_smfmac_f32_32x32x32_bf16 v[60:75], v[112:115], v[44:51], v124
  s_nop 0
  v_exp_f32 v57, v57
  v_exp_f32 v58, v58
  s_add_u32 s59, s59, 1
  v_exp_f32 v59, v59
  v_smfmac_f32_16x16x64_bf16 v[76:79], v[84:87], v[44:51], v124
  s_waitcnt lgkmcnt(1)
  v_mov_b32 v126, v127
  v_add_u32 v127, 32768, v127
  v_and_b32 v127, 0x1ffff, v127
  v_exp_f32 v28, v28
  v_exp_f32 v29, v29
  v_mfma_f32_32x32x16_bf16 v[160:175], v[120:123], v[144:147], 0
  v_smfmac_f32_32x32x32_bf16 v[60:75], v[116:119], v[52:59], v124
  ds_read_b128 v[88:91], v126 offset:8192
  v_exp_f32 v30, v30
  v_exp_f32 v31, v31
  buffer_store_dwordx4 v[144:147], v3, s[20:23], s4 offen sc1
  v_exp_f32 v32, v32
  v_smfmac_f32_16x16x64_bf16 v[80:83], v[84:87], v[52:59], v124
  ds_read_b128 v[92:95], v126 offset:9216
  v_exp_f32 v33, v33
  v_mfma_f32_32x32x16_bf16 v[44:59], v[96:99], v[4:7], v[12:27]
  ds_read_b128 v[112:115], v126 offset:6144
  v_exp_f32 v34, v34
  v_mfma_f32_32x32x16_bf16 v[160:175], v[120:123], v[148:151], v[160:175]
  v_exp_f32 v35, v35
  v_exp_f32 v36, v36
  v_mfma_f32_32x32x16_bf16 v[44:59], v[100:103], v[8:11], v[44:59]
  ds_read_b128 v[116:119], v126 offset:7168
  v_exp_f32 v37, v37
  v_exp_f32 v38, v38
  buffer_store_dwordx4 v[148:151], v3, s[20:23], s4 offen offset:1024 sc1
  s_add_u32 s4, s4, s13
  v_exp_f32 v39, v39
  v_exp_f32 v40, v40
  v_mfma_f32_32x32x16_bf16 v[176:191], v[120:123], v[152:155], 0
  v_smfmac_f32_32x32x32_bf16 v[60:75], v[104:107], v[28:35], v124
  s_nop 0
  v_exp_f32 v41, v41
  v_exp_f32 v42, v42
  v_exp_f32 v43, v43
  v_mfma_f32_32x32x16_bf16 v[176:191], v[120:123], v[156:159], v[176:191]
  v_smfmac_f32_16x16x64_bf16 v[76:79], v[84:87], v[28:35], v124
  s_waitcnt lgkmcnt(1)
  v_exp_f32 v44, v44
  v_exp_f32 v45, v45
  v_smfmac_f32_32x32x32_bf16 v[60:75], v[108:111], v[36:43], v124
  ds_read_b128 v[96:99], v126 offset:12288
  v_exp_f32 v46, v46
  v_exp_f32 v47, v47
  buffer_store_dwordx4 v[152:155], v3, s[20:23], s4 offen sc1
  v_exp_f32 v48, v48
  v_smfmac_f32_16x16x64_bf16 v[80:83], v[84:87], v[36:43], v124
  ds_read_b128 v[100:103], v126 offset:13312
  v_exp_f32 v49, v49
  v_mfma_f32_32x32x16_bf16 v[28:43], v[88:91], v[4:7], v[12:27]
  ds_read_b128 v[104:107], v126 offset:10240
  v_exp_f32 v50, v50
  v_exp_f32 v51, v51
  v_exp_f32 v52, v52
  v_mfma_f32_32x32x16_bf16 v[28:43], v[92:95], v[8:11], v[28:43]
  ds_read_b128 v[108:111], v126 offset:11264
  v_exp_f32 v53, v53
  v_exp_f32 v54, v54
  buffer_store_dwordx4 v[156:159], v3, s[20:23], s4 offen offset:1024 sc1
  s_add_u32 s4, s4, s13
  v_exp_f32 v55, v55
  v_exp_f32 v56, v56
  v_cndmask_b32 v194, v160, v176, vcc
  buffer_store_dword v194, v204, s[20:23], s14 offen offset:256 sc1
  v_smfmac_f32_32x32x32_bf16 v[60:75], v[112:115], v[44:51], v124
  s_nop 0
  v_exp_f32 v57, v57
  s_add_u32 s14, s14, 14336
  v_exp_f32 v58, v58
  v_exp_f32 v59, v59
  s_bitcmp1_b32 s29, s59
  v_smfmac_f32_16x16x64_bf16 v[76:79], v[84:87], v[44:51], v124
  s_waitcnt lgkmcnt(1)
  s_branch P2_barA
P2_specL:
  v_exp_f32 v28, v28
  v_exp_f32 v29, v29
  v_smfmac_f32_32x32x32_bf16 v[60:75], v[116:119], v[52:59], v124
  ds_read_b128 v[88:91], v127 offset:0
  v_exp_f32 v30, v30
  s_add_u32 m0, s58, 0
  v_exp_f32 v31, v31
  buffer_load_dwordx4 v125, s[16:19], s11 offen lds
  v_exp_f32 v32, v32
  v_smfmac_f32_16x16x64_bf16 v[80:83], v[84:87], v[52:59], v124
  ds_read_b128 v[92:95], v127 offset:1024
  v_exp_f32 v33, v33
  v_mfma_f32_32x32x16_bf16 v[44:59], v[96:99], v[4:7], v[12:27]
  ds_read_b128 v[112:115], v126 offset:14336
  v_exp_f32 v34, v34
  v_exp_f32 v35, v35
  v_exp_f32 v36, v36
  v_mfma_f32_32x32x16_bf16 v[44:59], v[100:103], v[8:11], v[44:59]
  ds_read_b128 v[116:119], v126 offset:15360
  v_exp_f32 v37, v37
  s_add_u32 m0, s58, 3968
  v_exp_f32 v38, v38
  buffer_load_dwordx4 v125, s[16:19], s11 offen offset:128 lds
  s_add_u32 s11, s11, s35
  v_exp_f32 v39, v39
  v_exp_f32 v40, v40
  v_smfmac_f32_32x32x32_bf16 v[60:75], v[104:107], v[28:35], v124
  s_nop 0
  v_exp_f32 v41, v41
  v_exp_f32 v42, v42
  v_exp_f32 v43, v43
  v_smfmac_f32_16x16x64_bf16 v[76:79], v[84:87], v[28:35], v124
  s_waitcnt lgkmcnt(1)
  v_exp_f32 v44, v44
  v_exp_f32 v45, v45
  v_smfmac_f32_32x32x32_bf16 v[60:75], v[108:111], v[36:43], v124
  ds_read_b128 v[96:99], v127 offset:4096
  v_exp_f32 v46, v46
  s_add_u32 m0, s58, 1024
  v_exp_f32 v47, v47
  buffer_load_dwordx4 v125, s[16:19], s11 offen lds
  v_exp_f32 v48, v48
  v_smfmac_f32_16x16x64_bf16 v[80:83], v[84:87], v[36:43], v124
  ds_read_b128 v[100:103], v127 offset:5120
  v_exp_f32 v49, v49
  v_mfma_f32_32x32x16_bf16 v[28:43], v[88:91], v[4:7], v[12:27]
  ds_read_b128 v[104:107], v127 offset:2048
  v_exp_f32 v50, v50
  v_exp_f32 v51, v51
  v_exp_f32 v52, v52
  v_mfma_f32_32x32x16_bf16 v[28:43], v[92:95], v[8:11], v[28:43]
  ds_read_b128 v[108:111], v127 offset:3072
  v_exp_f32 v53, v53
  s_add_u32 m0, s58, 4992
  v_exp_f32 v54, v54
  buffer_load_dwordx4 v125, s[16:19], s11 offen offset:128 lds
  s_add_u32 s11, s11, s35
  v_exp_f32 v55, v55
  v_exp_f32 v56, v56
  v_smfmac_f32_32x32x32_bf16 v[60:75], v[112:115], v[44:51], v124
  s_nop 0
  v_exp_f32 v57, v57
  v_exp_f32 v58, v58
  s_add_u32 s59, s59, 1
  v_exp_f32 v59, v59
  v_smfmac_f32_16x16x64_bf16 v[76:79], v[84:87], v[44:51], v124
  s_waitcnt lgkmcnt(1)
  v_mov_b32 v126, v127
  v_add_u32 v127, 32768, v127
  v_and_b32 v127, 0x1ffff, v127
  v_exp_f32 v28, v28
  v_exp_f32 v29, v29
  v_smfmac_f32_32x32x32_bf16 v[60:75], v[116:119], v[52:59], v124
  ds_read_b128 v[88:91], v126 offset:8192
  v_exp_f32 v30, v30
  s_add_u32 m0, s58, 2048
  v_exp_f32 v31, v31
  buffer_load_dwordx4 v125, s[16:19], s11 offen lds
  v_exp_f32 v32, v32
  v_smfmac_f32_16x16x64_bf16 v[80:83], v[84:87], v[52:59], v124
  ds_read_b128 v[92:95], v126 offset:9216
  v_exp_f32 v33, v33
  v_mfma_f32_32x32x16_bf16 v[44:59], v[96:99], v[4:7], v[12:27]
  ds_read_b128 v[112:115], v126 offset:6144
  v_exp_f32 v34, v34
  v_exp_f32 v35, v35
  v_exp_f32 v36, v36
  v_mfma_f32_32x32x16_bf16 v[44:59], v[100:103], v[8:11], v[44:59]
  ds_read_b128 v[116:119], v126 offset:7168
  v_exp_f32 v37, v37
  s_add_u32 m0, s58, 6016
  v_exp_f32 v38, v38
  buffer_load_dwordx4 v125, s[16:19], s11 offen offset:128 lds
  s_add_u32 s11, s11, s35
  v_exp_f32 v39, v39
  v_exp_f32 v40, v40
  v_smfmac_f32_32x32x32_bf16 v[60:75], v[104:107], v[28:35], v124
  s_nop 0
  v_exp_f32 v41, v41
  v_exp_f32 v42, v42
  v_exp_f32 v43, v43
  v_smfmac_f32_16x16x64_bf16 v[76:79], v[84:87], v[28:35], v124
  s_waitcnt lgkmcnt(1)
  v_exp_f32 v44, v44
  v_exp_f32 v45, v45
  v_smfmac_f32_32x32x32_bf16 v[60:75], v[108:111], v[36:43], v124
  ds_read_b128 v[96:99], v126 offset:12288
  v_exp_f32 v46, v46
  s_add_u32 m0, s58, 3072
  v_exp_f32 v47, v47
  buffer_load_dwordx4 v125, s[16:19], s11 offen lds
  v_exp_f32 v48, v48
  v_smfmac_f32_16x16x64_bf16 v[80:83], v[84:87], v[36:43], v124
  ds_read_b128 v[100:103], v126 offset:13312
  v_exp_f32 v49, v49
  v_mfma_f32_32x32x16_bf16 v[28:43], v[88:91], v[4:7], v[12:27]
  ds_read_b128 v[104:107], v126 offset:10240
  v_exp_f32 v50, v50
  v_exp_f32 v51, v51
  v_exp_f32 v52, v52
  v_mfma_f32_32x32x16_bf16 v[28:43], v[92:95], v[8:11], v[28:43]
  ds_read_b128 v[108:111], v126 offset:11264
  v_exp_f32 v53, v53
  s_add_u32 m0, s58, 7040
  v_exp_f32 v54, v54
  buffer_load_dwordx4 v125, s[16:19], s11 offen offset:128 lds
  s_add_u32 s11, s11, s35
  v_exp_f32 v55, v55
  v_exp_f32 v56, v56
  v_smfmac_f32_32x32x32_bf16 v[60:75], v[112:115], v[44:51], v124
  s_nop 0
  v_exp_f32 v57, v57
  v_exp_f32 v58, v58
  v_exp_f32 v59, v59
  s_bitcmp1_b32 s29, s59
  v_smfmac_f32_16x16x64_bf16 v[76:79], v[84:87], v[44:51], v124
  s_waitcnt lgkmcnt(1)
  s_branch P2_barA
P2_MA3:
  v_mov_b32 v128, s88
  s_mov_b64 exec, 1
  buffer_store_dword v128, off, s[20:23], s94 sc1
  s_mov_b64 exec, -1
  s_branch P2_contA
P2_fin:
  s_setprio 0
  v_smfmac_f32_32x32x32_bf16 v[60:75], v[116:119], v[52:59], v124
  v_smfmac_f32_16x16x64_bf16 v[80:83], v[84:87], v[52:59], v124
  s_lshl_b32 s10, s31, 6
  s_lshl_b32 s5, s28, 1
  s_add_u32 s10, s10, s5
  s_lshl_b32 s10, s10, 10
  s_add_u32 s10, s10, 12582912
  s_lshl_b32 s96, s86, 13
  s_lshl_b32 s5, s87, 5
  s_add_u32 s96, s96, s5
  s_lshl_b32 s5, s3, 2
  s_add_u32 s96, s96, s5
  s_add_u32 s96, s96, 56754176
  v_mov_b32 v131, 0x71800000
  v_mov_b32 v132, 0x7f800000
  v_and_b32 v130, 16, v2
  v_add_f32 v128, v76, v80
  v_cmp_ne_u32 vcc, 0, v130
  v_add_f32 v129, v77, v81
  s_nop 0
  v_cndmask_b32 v128, v128, v129, vcc
  v_max3_f32 v130, |v60|, |v61|, |v62|
  v_max3_f32 v130, v130, |v63|, |v64|
  v_max3_f32 v130, v130, |v65|, |v66|
  v_max3_f32 v130, v130, |v67|, |v68|
  v_max3_f32 v130, v130, |v69|, |v70|
  v_max3_f32 v130, v130, |v71|, |v72|
  v_max3_f32 v130, v130, |v73|, |v74|
  v_max_f32 v130, v130, |v75|
  v_cmp_nlt_f32 vcc, v128, v131
  v_cmp_nlt_f32 s[4:5], v130, v132
  s_nop 1
  s_or_b64 vcc, vcc, s[4:5]
  s_cbranch_vccnz P2_slow
P2_out:
  v_rcp_f32 v128, v128
  s_nop 0
  v_pk_mul_f32 v[60:61], v[60:61], v[128:129] op_sel_hi:[1,0]
  v_pk_mul_f32 v[62:63], v[62:63], v[128:129] op_sel_hi:[1,0]
  v_pk_mul_f32 v[64:65], v[64:65], v[128:129] op_sel_hi:[1,0]
  v_pk_mul_f32 v[66:67], v[66:67], v[128:129] op_sel_hi:[1,0]
  v_cvt_pk_bf16_f32 v60, v60, v61
  v_cvt_pk_bf16_f32 v61, v62, v63
  v_cvt_pk_bf16_f32 v62, v64, v65
  v_cvt_pk_bf16_f32 v63, v66, v67
  buffer_store_dwordx4 v[60:63], v3, s[20:23], s10 offen offset:0 sc1
  v_pk_mul_f32 v[68:69], v[68:69], v[128:129] op_sel_hi:[1,0]
  v_pk_mul_f32 v[70:71], v[70:71], v[128:129] op_sel_hi:[1,0]
  v_pk_mul_f32 v[72:73], v[72:73], v[128:129] op_sel_hi:[1,0]
  v_pk_mul_f32 v[74:75], v[74:75], v[128:129] op_sel_hi:[1,0]
  v_cvt_pk_bf16_f32 v68, v68, v69
  v_cvt_pk_bf16_f32 v69, v70, v71
  v_cvt_pk_bf16_f32 v70, v72, v73
  v_cvt_pk_bf16_f32 v71, v74, v75
  buffer_store_dwordx4 v[68:71], v3, s[20:23], s10 offen offset:1024 sc1
  s_waitcnt vmcnt(0)
  v_mov_b32 v128, s88
  v_lshlrev_b32 v129, 9, v2
  s_mov_b64 exec, 0xffff
  buffer_store_dword v128, v129, s[20:23], s96 offen sc1
  s_mov_b64 exec, -1
  s_waitcnt vmcnt(2) lgkmcnt(0)
  s_barrier
  s_cmp_lt_u32 s3, 4
  s_cbranch_scc1 K3_cons
  s_branch K3_load
P2_slow:
  s_lshl_b32 s6, s28, 18
  s_add_u32 s6, s6, 4194304
  s_mov_b32 s7, 64
  s_mov_b32 s8, s6
  v_mov_b32 v136, 0xff800000
P2_slow1:
  buffer_load_dwordx4 v[88:91], v3, s[20:23], s8 offen
  buffer_load_dwordx4 v[92:95], v3, s[20:23], s8 offen offset:1024
  s_waitcnt vmcnt(0)
  v_mfma_f32_32x32x16_bf16 v[28:43], v[88:91], v[4:7], 0
  v_mfma_f32_32x32x16_bf16 v[28:43], v[92:95], v[8:11], v[28:43]
  s_nop 7
  s_nop 7
  v_max3_f32 v128, v28, v29, v30
  v_max3_f32 v128, v128, v31, v32
  v_max3_f32 v128, v128, v33, v34
  v_max3_f32 v128, v128, v35, v36
  v_max3_f32 v128, v128, v37, v38
  v_max3_f32 v128, v128, v39, v40
  v_max3_f32 v128, v128, v41, v42
  v_max_f32 v128, v128, v43
  v_max_f32 v136, v136, v128
  s_add_u32 s8, s8, 4096
  s_sub_u32 s7, s7, 1
  s_cmp_lg_u32 s7, 0
  s_cbranch_scc1 P2_slow1
  v_mov_b32 v129, v136
  s_nop 1
  v_permlane32_swap_b32 v136, v129
  v_max_f32 v128, v136, v129
  v_sub_f32 v12, 0, v128
  v_mov_b32 v60, 0
  v_sub_f32 v13, 0, v128
  v_mov_b32 v61, 0
  v_sub_f32 v14, 0, v128
  v_mov_b32 v62, 0
  v_sub_f32 v15, 0, v128
  v_mov_b32 v63, 0
  v_sub_f32 v16, 0, v128
  v_mov_b32 v64, 0
  v_sub_f32 v17, 0, v128
  v_mov_b32 v65, 0
  v_sub_f32 v18, 0, v128
  v_mov_b32 v66, 0
  v_sub_f32 v19, 0, v128
  v_mov_b32 v67, 0
  v_sub_f32 v20, 0, v128
  v_mov_b32 v68, 0
  v_sub_f32 v21, 0, v128
  v_mov_b32 v69, 0
  v_sub_f32 v22, 0, v128
  v_mov_b32 v70, 0
  v_sub_f32 v23, 0, v128
  v_mov_b32 v71, 0
  v_sub_f32 v24, 0, v128
  v_mov_b32 v72, 0
  v_sub_f32 v25, 0, v128
  v_mov_b32 v73, 0
  v_sub_f32 v26, 0, v128
  v_mov_b32 v74, 0
  v_sub_f32 v27, 0, v128
  v_mov_b32 v75, 0
  v_mov_b32 v76, 0
  v_mov_b32 v77, 0
  v_mov_b32 v78, 0
  v_mov_b32 v79, 0
  v_mov_b32 v80, 0
  v_mov_b32 v81, 0
  v_mov_b32 v82, 0
  v_mov_b32 v83, 0
  s_mov_b32 s7, 64
  s_mov_b32 s8, s6
P2_slow2:
  buffer_load_dwordx4 v[88:91], v3, s[20:23], s8 offen
  buffer_load_dwordx4 v[92:95], v3, s[20:23], s8 offen offset:1024
  buffer_load_dwordx4 v[104:107], v3, s[20:23], s8 offen offset:2048
  buffer_load_dwordx4 v[108:111], v3, s[20:23], s8 offen offset:3072
  s_waitcnt vmcnt(0)
  v_mfma_f32_32x32x16_bf16 v[28:43], v[88:91], v[4:7], v[12:27]
  v_mfma_f32_32x32x16_bf16 v[28:43], v[92:95], v[8:11], v[28:43]
  s_nop 7
  s_nop 7
  v_exp_f32 v28, v28
  v_exp_f32 v29, v29
  v_exp_f32 v30, v30
  v_exp_f32 v31, v31
  v_exp_f32 v32, v32
  v_exp_f32 v33, v33
  v_exp_f32 v34, v34
  v_exp_f32 v35, v35
  v_exp_f32 v36, v36
  v_exp_f32 v37, v37
  v_exp_f32 v38, v38
  v_exp_f32 v39, v39
  v_exp_f32 v40, v40
  v_exp_f32 v41, v41
  v_exp_f32 v42, v42
  v_exp_f32 v43, v43
  s_nop 1
  v_smfmac_f32_32x32x32_bf16 v[60:75], v[104:107], v[28:35], v124
  v_smfmac_f32_16x16x64_bf16 v[76:79], v[84:87], v[28:35], v124
  v_smfmac_f32_32x32x32_bf16 v[60:75], v[108:111], v[36:43], v124
  v_smfmac_f32_16x16x64_bf16 v[80:83], v[84:87], v[36:43], v124
  s_add_u32 s8, s8, 4096
  s_sub_u32 s7, s7, 1
  s_cmp_lg_u32 s7, 0
  s_cbranch_scc1 P2_slow2
  s_nop 7
  s_nop 7
  v_and_b32 v130, 16, v2
  v_add_f32 v128, v76, v80
  v_cmp_ne_u32 vcc, 0, v130
  v_add_f32 v129, v77, v81
  s_nop 0
  v_cndmask_b32 v128, v128, v129, vcc
  s_branch P2_out
K3_cons:
  s_lshl_b32 s30, s89, 2
  s_add_u32 s30, s30, s3
  s_mov_b32 s12, s36
  s_mov_b32 s13, s37
  s_mov_b32 s14, 0x400000
  s_mov_b32 s15, 0x20000
  v_lshrrev_b32 v160, 3, v2
  v_and_b32 v163, 7, v2
  v_xor_b32 v163, v163, v160
  v_lshlrev_b32 v163, 4, v163
  v_lshl_add_u32 v160, v160, 11, v163
  s_lshl_b32 s4, s30, 16
  s_lshl_b32 s5, s90, 7
  s_add_u32 s4, s4, s5
  s_lshl_b32 s6, s3, 12
  s_add_u32 s6, s6, 147456
  v_and_b32 v161, 31, v2
  v_lshrrev_b32 v162, 5, v2
  v_lshlrev_b32 v162, 1, v162
  v_and_b32 v163, 7, v2
  v_xor_b32 v162, v162, v163
  v_lshlrev_b32 v162, 4, v162
  v_lshl_add_u32 v161, v161, 7, v162
  v_add_u32 v161, s6, v161
  s_add_u32 m0, s6, 0
  s_nop 0
  buffer_load_dwordx4 v160, s[12:15], s4 offen lds
  s_add_u32 m0, s6, 1024
  s_add_u32 s4, s4, 16384
  buffer_load_dwordx4 v160, s[12:15], s4 offen lds
  s_add_u32 m0, s6, 2048
  s_add_u32 s4, s4, 16384
  buffer_load_dwordx4 v160, s[12:15], s4 offen lds
  s_add_u32 m0, s6, 3072
  s_add_u32 s4, s4, 16384
  buffer_load_dwordx4 v160, s[12:15], s4 offen lds
  s_setprio 1
  s_lshl_b32 s4, s3, 12
  v_add_u32 v84, s4, v3
  v_add_u32 v85, 16384, v3
  v_mov_b32 v44, 0
  v_mov_b32 v45, 0
  v_mov_b32 v46, 0
  v_mov_b32 v47, 0
  v_mov_b32 v68, 0
  v_mov_b32 v69, 0
  v_mov_b32 v70, 0
  v_mov_b32 v71, 0
  v_mov_b32 v72, 0
  v_mov_b32 v73, 0
  v_mov_b32 v74, 0
  v_mov_b32 v75, 0
  v_mov_b32 v48, 0
  v_mov_b32 v49, 0
  v_mov_b32 v50, 0
  v_mov_b32 v51, 0
  v_mov_b32 v76, 0
  v_mov_b32 v77, 0
  v_mov_b32 v78, 0
  v_mov_b32 v79, 0
  v_mov_b32 v80, 0
  v_mov_b32 v81, 0
  v_mov_b32 v82, 0
  v_mov_b32 v83, 0
  s_mov_b32 s34, 0
  s_mov_b32 s35, 16
  s_mov_b32 s58, 0xfffe2000
  s_mov_b32 s59, 24576
  s_waitcnt vmcnt(0)
  v_xor_b32 v162, 0, v161
  ds_read_b128 v[164:167], v162
  v_xor_b32 v162, 16, v161
  ds_read_b128 v[168:171], v162
  v_xor_b32 v162, 64, v161
  ds_read_b128 v[172:175], v162
  v_xor_b32 v162, 80, v161
  ds_read_b128 v[176:179], v162
  s_waitcnt lgkmcnt(0)
  v_lshlrev_b32 v4, 16, v164
  v_and_b32 v5, 0xffff0000, v164
  v_lshlrev_b32 v6, 16, v165
  v_and_b32 v7, 0xffff0000, v165
  v_lshlrev_b32 v8, 16, v166
  v_and_b32 v9, 0xffff0000, v166
  v_lshlrev_b32 v10, 16, v167
  v_and_b32 v11, 0xffff0000, v167
  v_lshlrev_b32 v12, 16, v168
  v_and_b32 v13, 0xffff0000, v168
  v_lshlrev_b32 v14, 16, v169
  v_and_b32 v15, 0xffff0000, v169
  v_lshlrev_b32 v16, 16, v170
  v_and_b32 v17, 0xffff0000, v170
  v_lshlrev_b32 v18, 16, v171
  v_and_b32 v19, 0xffff0000, v171
  v_lshlrev_b32 v20, 16, v172
  v_and_b32 v21, 0xffff0000, v172
  v_lshlrev_b32 v22, 16, v173
  v_and_b32 v23, 0xffff0000, v173
  v_lshlrev_b32 v24, 16, v174
  v_and_b32 v25, 0xffff0000, v174
  v_lshlrev_b32 v26, 16, v175
  v_and_b32 v27, 0xffff0000, v175
  v_lshlrev_b32 v28, 16, v176
  v_and_b32 v29, 0xffff0000, v176
  v_lshlrev_b32 v30, 16, v177
  v_and_b32 v31, 0xffff0000, v177
  v_lshlrev_b32 v32, 16, v178
  v_and_b32 v33, 0xffff0000, v178
  v_lshlrev_b32 v34, 16, v179
  v_and_b32 v35, 0xffff0000, v179
  s_cmp_lg_u32 s3, 0
  s_cbranch_scc1 NP_7
  s_lshl_b32 s4, s89, 13
  s_add_u32 s4, s4, 56754176
  s_lshl_b32 s62, s90, 9
  s_add_u32 s4, s4, s62
  v_lshlrev_b32 v161, 3, v2
  s_mov_b32 s91, 200000
PTOP_9:
  buffer_load_dwordx2 v[164:165], v161, s[20:23], s4 offen sc1
  s_waitcnt vmcnt(0)
  v_cmp_ne_u32 vcc, s88, v164
  v_cmp_ne_u32 s[62:63], s88, v165
  s_nop 0
  s_or_b64 vcc, vcc, s[62:63]
  s_cbranch_vccz POK_8
  s_sleep 4
  s_sub_u32 s91, s91, 1
  s_cmp_lg_u32 s91, 0
  s_cbranch_scc1 PTOP_9
POK_8:
NP_7:
  s_barrier
K3_cloop:
  s_waitcnt lgkmcnt(0)
  s_barrier
  v_mfma_f32_32x32x16_bf16 v[4:19], v[68:71], v[44:47], v[4:19]
  ds_read_b128 v[36:39], v84 offset:0
  ds_read_b128 v[52:55], v85 offset:0
  v_mfma_f32_32x32x16_bf16 v[20:35], v[72:75], v[44:47], v[20:35]
  ds_read_b128 v[56:59], v85 offset:4096
  ds_read_b128 v[40:43], v84 offset:1024
  v_mfma_f32_32x32x16_bf16 v[4:19], v[76:79], v[48:51], v[4:19]
  ds_read_b128 v[60:63], v85 offset:1024
  ds_read_b128 v[64:67], v85 offset:5120
  v_mfma_f32_32x32x16_bf16 v[20:35], v[80:83], v[48:51], v[20:35]
  s_add_u32 s34, s34, 1
  s_cmp_eq_u32 s34, 6
  s_cselect_b32 s33, s58, s59
  s_cselect_b32 s34, 0, s34
  s_waitcnt lgkmcnt(0)
  v_mfma_f32_32x32x16_bf16 v[4:19], v[52:55], v[36:39], v[4:19]
  ds_read_b128 v[44:47], v84 offset:2048
  ds_read_b128 v[68:71], v85 offset:2048
  v_mfma_f32_32x32x16_bf16 v[20:35], v[56:59], v[36:39], v[20:35]
  ds_read_b128 v[72:75], v85 offset:6144
  ds_read_b128 v[48:51], v84 offset:3072
  v_mfma_f32_32x32x16_bf16 v[4:19], v[60:63], v[40:43], v[4:19]
  ds_read_b128 v[76:79], v85 offset:3072
  ds_read_b128 v[80:83], v85 offset:7168
  v_mfma_f32_32x32x16_bf16 v[20:35], v[64:67], v[40:43], v[20:35]
  v_add_u32 v84, s33, v84
  v_add_u32 v85, s33, v85
  s_sub_u32 s35, s35, 1
  s_cmp_lg_u32 s35, 0
  s_cbranch_scc1 K3_cloop
  s_waitcnt lgkmcnt(0)
  s_barrier
  v_mfma_f32_32x32x16_bf16 v[4:19], v[68:71], v[44:47], v[4:19]
  v_mfma_f32_32x32x16_bf16 v[20:35], v[72:75], v[44:47], v[20:35]
  v_mfma_f32_32x32x16_bf16 v[4:19], v[76:79], v[48:51], v[4:19]
  v_mfma_f32_32x32x16_bf16 v[20:35], v[80:83], v[48:51], v[20:35]
  v_mov_b32 v160, 0
  v_mov_b32 v161, 0
  v_mov_b32 v162, 0
  v_mov_b32 v163, 0
  v_mov_b32 v164, 0x3f803f80
  s_lshl_b32 s4, s30, 16
  s_lshl_b32 s5, s90, 12
  s_add_u32 s4, s4, s5
  s_add_u32 s4, s4, 16777216
  s_nop 4
  v_cvt_pk_bf16_f32 v4, v4, v5
  v_cvt_pk_bf16_f32 v5, v6, v7
  v_cvt_pk_bf16_f32 v6, v8, v9
  v_cvt_pk_bf16_f32 v7, v10, v11
  buffer_store_dwordx4 v[4:7], v3, s[20:23], s4 offen offset:0 sc1
  s_lshl_b32 s5, s3, 12
  v_add_u32 v165, s5, v3
  ds_write_b128 v165, v[4:7] offset:0
  v_cvt_pk_bf16_f32 v12, v12, v13
  v_cvt_pk_bf16_f32 v13, v14, v15
  v_cvt_pk_bf16_f32 v14, v16, v17
  v_cvt_pk_bf16_f32 v15, v18, v19
  buffer_store_dwordx4 v[12:15], v3, s[20:23], s4 offen offset:1024 sc1
  ds_write_b128 v165, v[12:15] offset:1024
  v_cvt_pk_bf16_f32 v20, v20, v21
  v_cvt_pk_bf16_f32 v21, v22, v23
  v_cvt_pk_bf16_f32 v22, v24, v25
  v_cvt_pk_bf16_f32 v23, v26, v27
  buffer_store_dwordx4 v[20:23], v3, s[20:23], s4 offen offset:2048 sc1
  ds_write_b128 v165, v[20:23] offset:2048
  v_cvt_pk_bf16_f32 v28, v28, v29
  v_cvt_pk_bf16_f32 v29, v30, v31
  v_cvt_pk_bf16_f32 v30, v32, v33
  v_cvt_pk_bf16_f32 v31, v34, v35
  buffer_store_dwordx4 v[28:31], v3, s[20:23], s4 offen offset:3072 sc1
  ds_write_b128 v165, v[28:31] offset:3072
  v_dot2c_f32_bf16 v160, v4, v164
  v_dot2c_f32_bf16 v161, v4, v4
  v_dot2c_f32_bf16 v162, v5, v164
  v_dot2c_f32_bf16 v163, v5, v5
  v_dot2c_f32_bf16 v160, v6, v164
  v_dot2c_f32_bf16 v161, v6, v6
  v_dot2c_f32_bf16 v162, v7, v164
  v_dot2c_f32_bf16 v163, v7, v7
  v_dot2c_f32_bf16 v160, v12, v164
  v_dot2c_f32_bf16 v161, v12, v12
  v_dot2c_f32_bf16 v162, v13, v164
  v_dot2c_f32_bf16 v163, v13, v13
  v_dot2c_f32_bf16 v160, v14, v164
  v_dot2c_f32_bf16 v161, v14, v14
  v_dot2c_f32_bf16 v162, v15, v164
  v_dot2c_f32_bf16 v163, v15, v15
  v_dot2c_f32_bf16 v160, v20, v164
  v_dot2c_f32_bf16 v161, v20, v20
  v_dot2c_f32_bf16 v162, v21, v164
  v_dot2c_f32_bf16 v163, v21, v21
  v_dot2c_f32_bf16 v160, v22, v164
  v_dot2c_f32_bf16 v161, v22, v22
  v_dot2c_f32_bf16 v162, v23, v164
  v_dot2c_f32_bf16 v163, v23, v23
  v_dot2c_f32_bf16 v160, v28, v164
  v_dot2c_f32_bf16 v161, v28, v28
  v_dot2c_f32_bf16 v162, v29, v164
  v_dot2c_f32_bf16 v163, v29, v29
  v_dot2c_f32_bf16 v160, v30, v164
  v_dot2c_f32_bf16 v161, v30, v30
  v_dot2c_f32_bf16 v162, v31, v164
  v_dot2c_f32_bf16 v163, v31, v31
  s_nop 2
  v_add_f32 v160, v160, v162
  v_add_f32 v161, v161, v163
  v_mov_b32 v162, v160
  v_mov_b32 v163, v161
  s_nop 1
  v_permlane32_swap_b32 v160, v162
  v_permlane32_swap_b32 v161, v163
  v_add_f32 v160, v160, v162
  v_add_f32 v161, v161, v163
  v_and_b32 v164, 31, v2
  v_lshlrev_b32 v164, 3, v164
  s_lshl_b32 s4, s90, 14
  s_lshl_b32 s5, s30, 8
  s_add_u32 s4, s4, s5
  s_add_u32 s4, s4, 53477376
  buffer_store_dwordx2 v[160:161], v164, s[20:23], s4 offen sc1
  s_setprio 0
K4_cons:
  s_lshl_b32 s96, s89, 13
  s_lshl_b32 s5, s90, 4
  s_add_u32 s96, s96, s5
  s_lshl_b32 s5, s3, 2
  s_add_u32 s96, s96, s5
  s_add_u32 s96, s96, 56885248
  s_setprio 1
  s_lshr_b32 s31, s3, 1
  s_and_b32 s32, s3, 1
  v_lshrrev_b32 v208, 4, v2
  v_lshlrev_b32 v208, 9, v208
  v_and_b32 v209, 15, v2
  v_lshl_add_u32 v207, v209, 4, v208
  s_lshl_b32 s4, s31, 13
  v_add_u32 v204, s4, v207
  s_lshl_b32 s4, s32, 14
  s_add_u32 s4, s4, 16384
  v_add_u32 v205, s4, v207
  s_lshl_b32 s4, s32, 8
  s_add_u32 s4, s4, 28672
  v_add_u32 v206, s4, v207
  s_mov_b32 s34, 0
  s_mov_b32 s35, 16
  s_mov_b32 s58, 0xfffea000
  s_mov_b32 s59, 45056
  v_add_u32 v248, 90112, v204
  v_add_u32 v249, 90112, v205
  v_add_u32 v250, 90112, v206
  s_waitcnt lgkmcnt(0)
  s_barrier
  ds_read_b128 v[116:119], v204 offset:0
  ds_read_b128 v[132:135], v205 offset:0
  ds_read_b128 v[120:123], v204 offset:256
  ds_read_b128 v[124:127], v204 offset:4096
  ds_read_b128 v[128:131], v204 offset:4352
  ds_read_b128 v[136:139], v205 offset:256
  ds_read_b128 v[140:143], v205 offset:4096
  ds_read_b128 v[144:147], v205 offset:4352
  ds_read_b128 v[148:151], v205 offset:8192
  ds_read_b128 v[152:155], v205 offset:8448
  ds_read_b128 v[156:159], v206 offset:0
  s_mov_b32 s35, 5
  s_waitcnt lgkmcnt(6)
  v_mfma_f32_16x16x32_bf16 v[4:7], v[132:135], v[116:119], 0
  ds_read_b128 v[160:163], v204 offset:2048
  v_mfma_f32_16x16x32_bf16 v[28:31], v[132:135], v[120:123], 0
  ds_read_b128 v[176:179], v205 offset:2048
  v_mfma_f32_16x16x32_bf16 v[52:55], v[132:135], v[124:127], 0
  ds_read_b128 v[164:167], v204 offset:2304
  v_mfma_f32_16x16x32_bf16 v[76:79], v[132:135], v[128:131], 0
  ds_read_b128 v[168:171], v204 offset:6144
  s_waitcnt lgkmcnt(4)
  v_mfma_f32_16x16x32_bf16 v[80:83], v[136:139], v[128:131], 0
  ds_read_b128 v[172:175], v204 offset:6400
  v_mfma_f32_16x16x32_bf16 v[56:59], v[136:139], v[124:127], 0
  ds_read_b128 v[180:183], v205 offset:2304
  v_mfma_f32_16x16x32_bf16 v[32:35], v[136:139], v[120:123], 0
  ds_read_b128 v[184:187], v205 offset:6144
  v_mfma_f32_16x16x32_bf16 v[8:11], v[136:139], v[116:119], 0
  ds_read_b128 v[188:191], v205 offset:6400
  v_mfma_f32_16x16x32_bf16 v[12:15], v[140:143], v[116:119], 0
  ds_read_b128 v[192:195], v205 offset:10240
  v_mfma_f32_16x16x32_bf16 v[36:39], v[140:143], v[120:123], 0
  ds_read_b128 v[196:199], v205 offset:10496
  v_mfma_f32_16x16x32_bf16 v[60:63], v[140:143], v[124:127], 0
  ds_read_b128 v[200:203], v206 offset:2048
  v_mfma_f32_16x16x32_bf16 v[84:87], v[140:143], v[128:131], 0
  v_mfma_f32_16x16x32_bf16 v[88:91], v[144:147], v[128:131], 0
  v_mfma_f32_16x16x32_bf16 v[64:67], v[144:147], v[124:127], 0
  v_mfma_f32_16x16x32_bf16 v[40:43], v[144:147], v[120:123], 0
  v_mfma_f32_16x16x32_bf16 v[16:19], v[144:147], v[116:119], 0
  v_mfma_f32_16x16x32_bf16 v[20:23], v[148:151], v[116:119], 0
  v_mfma_f32_16x16x32_bf16 v[44:47], v[148:151], v[120:123], 0
  v_mfma_f32_16x16x32_bf16 v[68:71], v[148:151], v[124:127], 0
  v_mfma_f32_16x16x32_bf16 v[92:95], v[148:151], v[128:131], 0
  v_mfma_f32_16x16x32_bf16 v[96:99], v[152:155], v[128:131], 0
  v_mfma_f32_16x16x32_bf16 v[72:75], v[152:155], v[124:127], 0
  v_mfma_f32_16x16x32_bf16 v[48:51], v[152:155], v[120:123], 0
  v_mfma_f32_16x16x32_bf16 v[24:27], v[152:155], v[116:119], 0
  v_mfma_f32_16x16x32_bf16 v[100:103], v[156:159], v[116:119], 0
  v_mfma_f32_16x16x32_bf16 v[104:107], v[156:159], v[120:123], 0
  v_mfma_f32_16x16x32_bf16 v[108:111], v[156:159], v[124:127], 0
  v_mfma_f32_16x16x32_bf16 v[112:115], v[156:159], v[128:131], 0
  s_waitcnt vmcnt(0)
  v_mov_b32 v208, s88
  v_lshlrev_b32 v209, 9, v2
  s_mov_b64 exec, 0xffff
  buffer_store_dword v208, v209, s[20:23], s96 offen sc1
  s_mov_b64 exec, -1
K4_cloop:
  s_waitcnt lgkmcnt(0)
  s_barrier
  v_mfma_f32_16x16x32_bf16 v[4:7], v[176:179], v[160:163], v[4:7]
  ds_read_b128 v[116:119], v204 offset:45056
  v_mfma_f32_16x16x32_bf16 v[28:31], v[176:179], v[164:167], v[28:31]
  ds_read_b128 v[132:135], v205 offset:45056
  v_mfma_f32_16x16x32_bf16 v[52:55], v[176:179], v[168:171], v[52:55]
  ds_read_b128 v[120:123], v204 offset:45312
  v_mfma_f32_16x16x32_bf16 v[76:79], v[176:179], v[172:175], v[76:79]
  ds_read_b128 v[124:127], v204 offset:49152
  v_mfma_f32_16x16x32_bf16 v[80:83], v[180:183], v[172:175], v[80:83]
  ds_read_b128 v[128:131], v204 offset:49408
  v_mfma_f32_16x16x32_bf16 v[56:59], v[180:183], v[168:171], v[56:59]
  ds_read_b128 v[136:139], v205 offset:45312
  v_mfma_f32_16x16x32_bf16 v[32:35], v[180:183], v[164:167], v[32:35]
  ds_read_b128 v[140:143], v205 offset:49152
  v_mfma_f32_16x16x32_bf16 v[8:11], v[180:183], v[160:163], v[8:11]
  ds_read_b128 v[144:147], v205 offset:49408
  v_mfma_f32_16x16x32_bf16 v[12:15], v[184:187], v[160:163], v[12:15]
  ds_read_b128 v[148:151], v205 offset:53248
  v_mfma_f32_16x16x32_bf16 v[36:39], v[184:187], v[164:167], v[36:39]
  ds_read_b128 v[152:155], v205 offset:53504
  v_mfma_f32_16x16x32_bf16 v[60:63], v[184:187], v[168:171], v[60:63]
  ds_read_b128 v[156:159], v206 offset:45056
  v_mfma_f32_16x16x32_bf16 v[84:87], v[184:187], v[172:175], v[84:87]
  v_mfma_f32_16x16x32_bf16 v[88:91], v[188:191], v[172:175], v[88:91]
  v_mfma_f32_16x16x32_bf16 v[64:67], v[188:191], v[168:171], v[64:67]
  v_mfma_f32_16x16x32_bf16 v[40:43], v[188:191], v[164:167], v[40:43]
  v_mfma_f32_16x16x32_bf16 v[16:19], v[188:191], v[160:163], v[16:19]
  v_mfma_f32_16x16x32_bf16 v[20:23], v[192:195], v[160:163], v[20:23]
  v_mfma_f32_16x16x32_bf16 v[44:47], v[192:195], v[164:167], v[44:47]
  v_mfma_f32_16x16x32_bf16 v[68:71], v[192:195], v[168:171], v[68:71]
  v_mfma_f32_16x16x32_bf16 v[92:95], v[192:195], v[172:175], v[92:95]
  v_mfma_f32_16x16x32_bf16 v[96:99], v[196:199], v[172:175], v[96:99]
  v_mfma_f32_16x16x32_bf16 v[72:75], v[196:199], v[168:171], v[72:75]
  v_mfma_f32_16x16x32_bf16 v[48:51], v[196:199], v[164:167], v[48:51]
  v_mfma_f32_16x16x32_bf16 v[24:27], v[196:199], v[160:163], v[24:27]
  v_mfma_f32_16x16x32_bf16 v[100:103], v[200:203], v[160:163], v[100:103]
  v_mfma_f32_16x16x32_bf16 v[104:107], v[200:203], v[164:167], v[104:107]
  v_mfma_f32_16x16x32_bf16 v[108:111], v[200:203], v[168:171], v[108:111]
  v_mfma_f32_16x16x32_bf16 v[112:115], v[200:203], v[172:175], v[112:115]
  s_waitcnt lgkmcnt(0)
  v_mfma_f32_16x16x32_bf16 v[4:7], v[132:135], v[116:119], v[4:7]
  ds_read_b128 v[160:163], v204 offset:47104
  v_mfma_f32_16x16x32_bf16 v[28:31], v[132:135], v[120:123], v[28:31]
  ds_read_b128 v[176:179], v205 offset:47104
  v_mfma_f32_16x16x32_bf16 v[52:55], v[132:135], v[124:127], v[52:55]
  ds_read_b128 v[164:167], v204 offset:47360
  v_mfma_f32_16x16x32_bf16 v[76:79], v[132:135], v[128:131], v[76:79]
  ds_read_b128 v[168:171], v204 offset:51200
  v_mfma_f32_16x16x32_bf16 v[80:83], v[136:139], v[128:131], v[80:83]
  ds_read_b128 v[172:175], v204 offset:51456
  v_mfma_f32_16x16x32_bf16 v[56:59], v[136:139], v[124:127], v[56:59]
  ds_read_b128 v[180:183], v205 offset:47360
  v_mfma_f32_16x16x32_bf16 v[32:35], v[136:139], v[120:123], v[32:35]
  ds_read_b128 v[184:187], v205 offset:51200
  v_mfma_f32_16x16x32_bf16 v[8:11], v[136:139], v[116:119], v[8:11]
  ds_read_b128 v[188:191], v205 offset:51456
  v_mfma_f32_16x16x32_bf16 v[12:15], v[140:143], v[116:119], v[12:15]
  ds_read_b128 v[192:195], v205 offset:55296
  v_mfma_f32_16x16x32_bf16 v[36:39], v[140:143], v[120:123], v[36:39]
  ds_read_b128 v[196:199], v205 offset:55552
  v_mfma_f32_16x16x32_bf16 v[60:63], v[140:143], v[124:127], v[60:63]
  ds_read_b128 v[200:203], v206 offset:47104
  v_mfma_f32_16x16x32_bf16 v[84:87], v[140:143], v[128:131], v[84:87]
  v_mfma_f32_16x16x32_bf16 v[88:91], v[144:147], v[128:131], v[88:91]
  v_mfma_f32_16x16x32_bf16 v[64:67], v[144:147], v[124:127], v[64:67]
  v_mfma_f32_16x16x32_bf16 v[40:43], v[144:147], v[120:123], v[40:43]
  v_mfma_f32_16x16x32_bf16 v[16:19], v[144:147], v[116:119], v[16:19]
  v_mfma_f32_16x16x32_bf16 v[20:23], v[148:151], v[116:119], v[20:23]
  v_mfma_f32_16x16x32_bf16 v[44:47], v[148:151], v[120:123], v[44:47]
  v_mfma_f32_16x16x32_bf16 v[68:71], v[148:151], v[124:127], v[68:71]
  v_mfma_f32_16x16x32_bf16 v[92:95], v[148:151], v[128:131], v[92:95]
  v_mfma_f32_16x16x32_bf16 v[96:99], v[152:155], v[128:131], v[96:99]
  v_mfma_f32_16x16x32_bf16 v[72:75], v[152:155], v[124:127], v[72:75]
  v_mfma_f32_16x16x32_bf16 v[48:51], v[152:155], v[120:123], v[48:51]
  v_mfma_f32_16x16x32_bf16 v[24:27], v[152:155], v[116:119], v[24:27]
  v_mfma_f32_16x16x32_bf16 v[100:103], v[156:159], v[116:119], v[100:103]
  v_mfma_f32_16x16x32_bf16 v[104:107], v[156:159], v[120:123], v[104:107]
  v_mfma_f32_16x16x32_bf16 v[108:111], v[156:159], v[124:127], v[108:111]
  v_mfma_f32_16x16x32_bf16 v[112:115], v[156:159], v[128:131], v[112:115]
  s_waitcnt lgkmcnt(0)
  s_barrier
  v_mfma_f32_16x16x32_bf16 v[4:7], v[176:179], v[160:163], v[4:7]
  ds_read_b128 v[116:119], v248 offset:0
  v_mfma_f32_16x16x32_bf16 v[28:31], v[176:179], v[164:167], v[28:31]
  ds_read_b128 v[132:135], v249 offset:0
  v_mfma_f32_16x16x32_bf16 v[52:55], v[176:179], v[168:171], v[52:55]
  ds_read_b128 v[120:123], v248 offset:256
  v_mfma_f32_16x16x32_bf16 v[76:79], v[176:179], v[172:175], v[76:79]
  ds_read_b128 v[124:127], v248 offset:4096
  v_mfma_f32_16x16x32_bf16 v[80:83], v[180:183], v[172:175], v[80:83]
  ds_read_b128 v[128:131], v248 offset:4352
  v_mfma_f32_16x16x32_bf16 v[56:59], v[180:183], v[168:171], v[56:59]
  ds_read_b128 v[136:139], v249 offset:256
  v_mfma_f32_16x16x32_bf16 v[32:35], v[180:183], v[164:167], v[32:35]
  ds_read_b128 v[140:143], v249 offset:4096
  v_mfma_f32_16x16x32_bf16 v[8:11], v[180:183], v[160:163], v[8:11]
  ds_read_b128 v[144:147], v249 offset:4352
  v_mfma_f32_16x16x32_bf16 v[12:15], v[184:187], v[160:163], v[12:15]
  ds_read_b128 v[148:151], v249 offset:8192
  v_mfma_f32_16x16x32_bf16 v[36:39], v[184:187], v[164:167], v[36:39]
  ds_read_b128 v[152:155], v249 offset:8448
  v_mfma_f32_16x16x32_bf16 v[60:63], v[184:187], v[168:171], v[60:63]
  ds_read_b128 v[156:159], v250 offset:0
  v_mfma_f32_16x16x32_bf16 v[84:87], v[184:187], v[172:175], v[84:87]
  v_mfma_f32_16x16x32_bf16 v[88:91], v[188:191], v[172:175], v[88:91]
  v_mfma_f32_16x16x32_bf16 v[64:67], v[188:191], v[168:171], v[64:67]
  v_mfma_f32_16x16x32_bf16 v[40:43], v[188:191], v[164:167], v[40:43]
  v_mfma_f32_16x16x32_bf16 v[16:19], v[188:191], v[160:163], v[16:19]
  v_mfma_f32_16x16x32_bf16 v[20:23], v[192:195], v[160:163], v[20:23]
  v_mfma_f32_16x16x32_bf16 v[44:47], v[192:195], v[164:167], v[44:47]
  v_mfma_f32_16x16x32_bf16 v[68:71], v[192:195], v[168:171], v[68:71]
  v_mfma_f32_16x16x32_bf16 v[92:95], v[192:195], v[172:175], v[92:95]
  v_mfma_f32_16x16x32_bf16 v[96:99], v[196:199], v[172:175], v[96:99]
  v_mfma_f32_16x16x32_bf16 v[72:75], v[196:199], v[168:171], v[72:75]
  v_mfma_f32_16x16x32_bf16 v[48:51], v[196:199], v[164:167], v[48:51]
  v_mfma_f32_16x16x32_bf16 v[24:27], v[196:199], v[160:163], v[24:27]
  v_mfma_f32_16x16x32_bf16 v[100:103], v[200:203], v[160:163], v[100:103]
  v_mfma_f32_16x16x32_bf16 v[104:107], v[200:203], v[164:167], v[104:107]
  v_mfma_f32_16x16x32_bf16 v[108:111], v[200:203], v[168:171], v[108:111]
  v_mfma_f32_16x16x32_bf16 v[112:115], v[200:203], v[172:175], v[112:115]
  s_waitcnt lgkmcnt(0)
  v_mfma_f32_16x16x32_bf16 v[4:7], v[132:135], v[116:119], v[4:7]
  ds_read_b128 v[160:163], v248 offset:2048
  v_mfma_f32_16x16x32_bf16 v[28:31], v[132:135], v[120:123], v[28:31]
  ds_read_b128 v[176:179], v249 offset:2048
  v_mfma_f32_16x16x32_bf16 v[52:55], v[132:135], v[124:127], v[52:55]
  ds_read_b128 v[164:167], v248 offset:2304
  v_mfma_f32_16x16x32_bf16 v[76:79], v[132:135], v[128:131], v[76:79]
  ds_read_b128 v[168:171], v248 offset:6144
  v_mfma_f32_16x16x32_bf16 v[80:83], v[136:139], v[128:131], v[80:83]
  ds_read_b128 v[172:175], v248 offset:6400
  v_mfma_f32_16x16x32_bf16 v[56:59], v[136:139], v[124:127], v[56:59]
  ds_read_b128 v[180:183], v249 offset:2304
  v_mfma_f32_16x16x32_bf16 v[32:35], v[136:139], v[120:123], v[32:35]
  ds_read_b128 v[184:187], v249 offset:6144
  v_mfma_f32_16x16x32_bf16 v[8:11], v[136:139], v[116:119], v[8:11]
  ds_read_b128 v[188:191], v249 offset:6400
  v_mfma_f32_16x16x32_bf16 v[12:15], v[140:143], v[116:119], v[12:15]
  ds_read_b128 v[192:195], v249 offset:10240
  v_mfma_f32_16x16x32_bf16 v[36:39], v[140:143], v[120:123], v[36:39]
  ds_read_b128 v[196:199], v249 offset:10496
  v_mfma_f32_16x16x32_bf16 v[60:63], v[140:143], v[124:127], v[60:63]
  ds_read_b128 v[200:203], v250 offset:2048
  v_mfma_f32_16x16x32_bf16 v[84:87], v[140:143], v[128:131], v[84:87]
  v_mfma_f32_16x16x32_bf16 v[88:91], v[144:147], v[128:131], v[88:91]
  v_mfma_f32_16x16x32_bf16 v[64:67], v[144:147], v[124:127], v[64:67]
  v_mfma_f32_16x16x32_bf16 v[40:43], v[144:147], v[120:123], v[40:43]
  v_mfma_f32_16x16x32_bf16 v[16:19], v[144:147], v[116:119], v[16:19]
  v_mfma_f32_16x16x32_bf16 v[20:23], v[148:151], v[116:119], v[20:23]
  v_mfma_f32_16x16x32_bf16 v[44:47], v[148:151], v[120:123], v[44:47]
  v_mfma_f32_16x16x32_bf16 v[68:71], v[148:151], v[124:127], v[68:71]
  v_mfma_f32_16x16x32_bf16 v[92:95], v[148:151], v[128:131], v[92:95]
  v_mfma_f32_16x16x32_bf16 v[96:99], v[152:155], v[128:131], v[96:99]
  v_mfma_f32_16x16x32_bf16 v[72:75], v[152:155], v[124:127], v[72:75]
  v_mfma_f32_16x16x32_bf16 v[48:51], v[152:155], v[120:123], v[48:51]
  v_mfma_f32_16x16x32_bf16 v[24:27], v[152:155], v[116:119], v[24:27]
  v_mfma_f32_16x16x32_bf16 v[100:103], v[156:159], v[116:119], v[100:103]
  v_mfma_f32_16x16x32_bf16 v[104:107], v[156:159], v[120:123], v[104:107]
  v_mfma_f32_16x16x32_bf16 v[108:111], v[156:159], v[124:127], v[108:111]
  v_mfma_f32_16x16x32_bf16 v[112:115], v[156:159], v[128:131], v[112:115]
  s_waitcnt lgkmcnt(0)
  s_barrier
  v_mfma_f32_16x16x32_bf16 v[4:7], v[176:179], v[160:163], v[4:7]
  ds_read_b128 v[116:119], v204 offset:0
  v_mfma_f32_16x16x32_bf16 v[28:31], v[176:179], v[164:167], v[28:31]
  ds_read_b128 v[132:135], v205 offset:0
  v_mfma_f32_16x16x32_bf16 v[52:55], v[176:179], v[168:171], v[52:55]
  ds_read_b128 v[120:123], v204 offset:256
  v_mfma_f32_16x16x32_bf16 v[76:79], v[176:179], v[172:175], v[76:79]
  ds_read_b128 v[124:127], v204 offset:4096
  v_mfma_f32_16x16x32_bf16 v[80:83], v[180:183], v[172:175], v[80:83]
  ds_read_b128 v[128:131], v204 offset:4352
  v_mfma_f32_16x16x32_bf16 v[56:59], v[180:183], v[168:171], v[56:59]
  ds_read_b128 v[136:139], v205 offset:256
  v_mfma_f32_16x16x32_bf16 v[32:35], v[180:183], v[164:167], v[32:35]
  ds_read_b128 v[140:143], v205 offset:4096
  v_mfma_f32_16x16x32_bf16 v[8:11], v[180:183], v[160:163], v[8:11]
  ds_read_b128 v[144:147], v205 offset:4352
  v_mfma_f32_16x16x32_bf16 v[12:15], v[184:187], v[160:163], v[12:15]
  ds_read_b128 v[148:151], v205 offset:8192
  v_mfma_f32_16x16x32_bf16 v[36:39], v[184:187], v[164:167], v[36:39]
  ds_read_b128 v[152:155], v205 offset:8448
  v_mfma_f32_16x16x32_bf16 v[60:63], v[184:187], v[168:171], v[60:63]
  ds_read_b128 v[156:159], v206 offset:0
  v_mfma_f32_16x16x32_bf16 v[84:87], v[184:187], v[172:175], v[84:87]
  v_mfma_f32_16x16x32_bf16 v[88:91], v[188:191], v[172:175], v[88:91]
  v_mfma_f32_16x16x32_bf16 v[64:67], v[188:191], v[168:171], v[64:67]
  v_mfma_f32_16x16x32_bf16 v[40:43], v[188:191], v[164:167], v[40:43]
  v_mfma_f32_16x16x32_bf16 v[16:19], v[188:191], v[160:163], v[16:19]
  v_mfma_f32_16x16x32_bf16 v[20:23], v[192:195], v[160:163], v[20:23]
  v_mfma_f32_16x16x32_bf16 v[44:47], v[192:195], v[164:167], v[44:47]
  v_mfma_f32_16x16x32_bf16 v[68:71], v[192:195], v[168:171], v[68:71]
  v_mfma_f32_16x16x32_bf16 v[92:95], v[192:195], v[172:175], v[92:95]
  v_mfma_f32_16x16x32_bf16 v[96:99], v[196:199], v[172:175], v[96:99]
  v_mfma_f32_16x16x32_bf16 v[72:75], v[196:199], v[168:171], v[72:75]
  v_mfma_f32_16x16x32_bf16 v[48:51], v[196:199], v[164:167], v[48:51]
  v_mfma_f32_16x16x32_bf16 v[24:27], v[196:199], v[160:163], v[24:27]
  v_mfma_f32_16x16x32_bf16 v[100:103], v[200:203], v[160:163], v[100:103]
  v_mfma_f32_16x16x32_bf16 v[104:107], v[200:203], v[164:167], v[104:107]
  v_mfma_f32_16x16x32_bf16 v[108:111], v[200:203], v[168:171], v[108:111]
  v_mfma_f32_16x16x32_bf16 v[112:115], v[200:203], v[172:175], v[112:115]
  s_waitcnt lgkmcnt(0)
  v_mfma_f32_16x16x32_bf16 v[4:7], v[132:135], v[116:119], v[4:7]
  ds_read_b128 v[160:163], v204 offset:2048
  v_mfma_f32_16x16x32_bf16 v[28:31], v[132:135], v[120:123], v[28:31]
  ds_read_b128 v[176:179], v205 offset:2048
  v_mfma_f32_16x16x32_bf16 v[52:55], v[132:135], v[124:127], v[52:55]
  ds_read_b128 v[164:167], v204 offset:2304
  v_mfma_f32_16x16x32_bf16 v[76:79], v[132:135], v[128:131], v[76:79]
  ds_read_b128 v[168:171], v204 offset:6144
  v_mfma_f32_16x16x32_bf16 v[80:83], v[136:139], v[128:131], v[80:83]
  ds_read_b128 v[172:175], v204 offset:6400
  v_mfma_f32_16x16x32_bf16 v[56:59], v[136:139], v[124:127], v[56:59]
  ds_read_b128 v[180:183], v205 offset:2304
  v_mfma_f32_16x16x32_bf16 v[32:35], v[136:139], v[120:123], v[32:35]
  ds_read_b128 v[184:187], v205 offset:6144
  v_mfma_f32_16x16x32_bf16 v[8:11], v[136:139], v[116:119], v[8:11]
  ds_read_b128 v[188:191], v205 offset:6400
  v_mfma_f32_16x16x32_bf16 v[12:15], v[140:143], v[116:119], v[12:15]
  ds_read_b128 v[192:195], v205 offset:10240
  v_mfma_f32_16x16x32_bf16 v[36:39], v[140:143], v[120:123], v[36:39]
  ds_read_b128 v[196:199], v205 offset:10496
  v_mfma_f32_16x16x32_bf16 v[60:63], v[140:143], v[124:127], v[60:63]
  ds_read_b128 v[200:203], v206 offset:2048
  v_mfma_f32_16x16x32_bf16 v[84:87], v[140:143], v[128:131], v[84:87]
  s_sub_u32 s35, s35, 1
  v_mfma_f32_16x16x32_bf16 v[88:91], v[144:147], v[128:131], v[88:91]
  s_cmp_lg_u32 s35, 0
  v_mfma_f32_16x16x32_bf16 v[64:67], v[144:147], v[124:127], v[64:67]
  v_mfma_f32_16x16x32_bf16 v[40:43], v[144:147], v[120:123], v[40:43]
  v_mfma_f32_16x16x32_bf16 v[16:19], v[144:147], v[116:119], v[16:19]
  v_mfma_f32_16x16x32_bf16 v[20:23], v[148:151], v[116:119], v[20:23]
  v_mfma_f32_16x16x32_bf16 v[44:47], v[148:151], v[120:123], v[44:47]
  v_mfma_f32_16x16x32_bf16 v[68:71], v[148:151], v[124:127], v[68:71]
  v_mfma_f32_16x16x32_bf16 v[92:95], v[148:151], v[128:131], v[92:95]
  v_mfma_f32_16x16x32_bf16 v[96:99], v[152:155], v[128:131], v[96:99]
  v_mfma_f32_16x16x32_bf16 v[72:75], v[152:155], v[124:127], v[72:75]
  v_mfma_f32_16x16x32_bf16 v[48:51], v[152:155], v[120:123], v[48:51]
  v_mfma_f32_16x16x32_bf16 v[24:27], v[152:155], v[116:119], v[24:27]
  v_mfma_f32_16x16x32_bf16 v[100:103], v[156:159], v[116:119], v[100:103]
  v_mfma_f32_16x16x32_bf16 v[104:107], v[156:159], v[120:123], v[104:107]
  v_mfma_f32_16x16x32_bf16 v[108:111], v[156:159], v[124:127], v[108:111]
  v_mfma_f32_16x16x32_bf16 v[112:115], v[156:159], v[128:131], v[112:115]
  s_cbranch_scc1 K4_cloop
  s_waitcnt lgkmcnt(0)
  s_barrier
  v_mfma_f32_16x16x32_bf16 v[4:7], v[176:179], v[160:163], v[4:7]
  s_mov_b32 s8, 0xbeeff558
  v_mfma_f32_16x16x32_bf16 v[28:31], v[176:179], v[164:167], v[28:31]
  s_mov_b32 s9, 0xbeeff558
  v_mfma_f32_16x16x32_bf16 v[52:55], v[176:179], v[168:171], v[52:55]
  v_mov_b32 v232, 0x409d30fc
  v_mfma_f32_16x16x32_bf16 v[76:79], v[176:179], v[172:175], v[76:79]
  v_mov_b32 v233, 0x409d30fc
  v_mfma_f32_16x16x32_bf16 v[80:83], v[180:183], v[172:175], v[80:83]
  v_and_b32 v216, 15, v2
  v_mfma_f32_16x16x32_bf16 v[56:59], v[180:183], v[168:171], v[56:59]
  v_lshlrev_b32 v216, 2, v216
  v_mfma_f32_16x16x32_bf16 v[32:35], v[180:183], v[164:167], v[32:35]
  s_lshl_b32 s5, s31, 8
  v_mfma_f32_16x16x32_bf16 v[8:11], v[180:183], v[160:163], v[8:11]
  s_add_u32 s5, s5, 147456
  v_mfma_f32_16x16x32_bf16 v[12:15], v[184:187], v[160:163], v[12:15]
  v_add_u32 v216, s5, v216
  v_mfma_f32_16x16x32_bf16 v[36:39], v[184:187], v[164:167], v[36:39]
  ds_read2_b32 v[208:209], v216 offset0:0 offset1:128
  v_mfma_f32_16x16x32_bf16 v[60:63], v[184:187], v[168:171], v[60:63]
  ds_read2_b32 v[210:211], v216 offset0:16 offset1:144
  v_mfma_f32_16x16x32_bf16 v[84:87], v[184:187], v[172:175], v[84:87]
  ds_read2_b32 v[212:213], v216 offset0:32 offset1:160
  v_mfma_f32_16x16x32_bf16 v[88:91], v[188:191], v[172:175], v[88:91]
  ds_read2_b32 v[214:215], v216 offset0:48 offset1:176
  v_mfma_f32_16x16x32_bf16 v[64:67], v[188:191], v[168:171], v[64:67]
  v_bfe_u32 v217, v2, 4, 1
  v_mfma_f32_16x16x32_bf16 v[40:43], v[188:191], v[164:167], v[40:43]
  v_lshlrev_b32 v217, 6, v217
  v_mfma_f32_16x16x32_bf16 v[16:19], v[188:191], v[160:163], v[16:19]
  v_lshrrev_b32 v218, 5, v2
  v_mfma_f32_16x16x32_bf16 v[20:23], v[192:195], v[160:163], v[20:23]
  v_lshl_add_u32 v217, v218, 4, v217
  v_mfma_f32_16x16x32_bf16 v[44:47], v[192:195], v[164:167], v[44:47]
  s_lshl_b32 s5, s32, 9
  v_mfma_f32_16x16x32_bf16 v[68:71], v[192:195], v[168:171], v[68:71]
  s_add_u32 s5, s5, 148480
  v_mfma_f32_16x16x32_bf16 v[92:95], v[192:195], v[172:175], v[92:95]
  v_add_u32 v234, s5, v217
  v_mfma_f32_16x16x32_bf16 v[96:99], v[196:199], v[172:175], v[96:99]
  s_lshl_b32 s5, s32, 5
  v_mfma_f32_16x16x32_bf16 v[72:75], v[196:199], v[168:171], v[72:75]
  s_add_u32 s5, s5, 148864
  v_mfma_f32_16x16x32_bf16 v[48:51], v[196:199], v[164:167], v[48:51]
  v_add_u32 v235, s5, v217
  v_mfma_f32_16x16x32_bf16 v[24:27], v[196:199], v[160:163], v[24:27]
  ds_read_b128 v[116:119], v234 offset:0
  v_mfma_f32_16x16x32_bf16 v[100:103], v[200:203], v[160:163], v[100:103]
  ds_read_b128 v[120:123], v234 offset:1024
  v_mfma_f32_16x16x32_bf16 v[104:107], v[200:203], v[164:167], v[104:107]
  ds_read_b128 v[124:127], v234 offset:32
  v_mfma_f32_16x16x32_bf16 v[108:111], v[200:203], v[168:171], v[108:111]
  ds_read_b128 v[128:131], v234 offset:1056
  v_mfma_f32_16x16x32_bf16 v[112:115], v[200:203], v[172:175], v[112:115]
  ds_read_b128 v[132:135], v234 offset:128
  ds_read_b128 v[136:139], v234 offset:1152
  ds_read_b128 v[140:143], v234 offset:160
  ds_read_b128 v[144:147], v234 offset:1184
  ds_read_b128 v[148:151], v235 offset:0
  ds_read_b128 v[152:155], v235 offset:1024
  v_and_b32 v236, 0x3ff, v207
  v_lshl_add_u32 v236, v218, 8, v236
  s_lshl_b32 s4, s89, 2
  s_lshl_b32 s5, s31, 1
  s_add_u32 s4, s4, s5
  s_mul_i32 s4, s4, 229376
  s_mul_i32 s5, s90, 14336
  s_add_u32 s4, s4, s5
  s_add_u32 s4, s4, 20971520
  s_lshl_b32 s5, s32, 10
  s_add_u32 s10, s4, s5
  s_add_u32 s10, s10, 6144
  s_add_u32 s11, s10, 229376
  s_lshl_b32 s5, s32, 13
  s_add_u32 s4, s4, s5
  s_add_u32 s5, s4, 229376
  s_lshl_b32 s26, s31, 13
  s_lshl_b32 s27, s32, 16
  s_add_u32 s27, s27, s26
  v_add_u32 v240, s27, v207
  s_lshl_b32 s27, s32, 10
  s_add_u32 s27, s27, s26
  s_add_u32 s27, s27, 34816
  v_add_u32 v241, s27, v236
  s_waitcnt lgkmcnt(0)
  v_pk_fma_f32 v[216:217], v[120:121], v[208:209], v[116:117] op_sel:[0,1,0] op_sel_hi:[1,1,1]
  v_pk_fma_f32 v[218:219], v[122:123], v[208:209], v[118:119] op_sel:[0,1,0] op_sel_hi:[1,1,1]
  v_pk_fma_f32 v[220:221], v[128:129], v[208:209], v[124:125] op_sel:[0,1,0] op_sel_hi:[1,1,1]
  v_pk_fma_f32 v[222:223], v[130:131], v[208:209], v[126:127] op_sel:[0,1,0] op_sel_hi:[1,1,1]
  v_pk_fma_f32 v[4:5], v[4:5], v[208:209], v[216:217] op_sel:[0,0,0] op_sel_hi:[1,0,1]
  v_pk_fma_f32 v[6:7], v[6:7], v[208:209], v[218:219] op_sel:[0,0,0] op_sel_hi:[1,0,1]
  v_pk_fma_f32 v[8:9], v[8:9], v[208:209], v[220:221] op_sel:[0,0,0] op_sel_hi:[1,0,1]
  v_pk_fma_f32 v[10:11], v[10:11], v[208:209], v[222:223] op_sel:[0,0,0] op_sel_hi:[1,0,1]
  v_pk_fma_f32 v[216:217], v[4:5], v[4:5], v[232:233]
  v_pk_fma_f32 v[218:219], v[6:7], v[6:7], v[232:233]
  v_pk_fma_f32 v[220:221], v[8:9], v[8:9], v[232:233]
  v_pk_fma_f32 v[222:223], v[10:11], v[10:11], v[232:233]
  v_pk_mul_f32 v[216:217], v[216:217], v[4:5]
  v_pk_mul_f32 v[218:219], v[218:219], v[6:7]
  v_pk_mul_f32 v[220:221], v[220:221], v[8:9]
  v_pk_mul_f32 v[222:223], v[222:223], v[10:11]
  v_exp_f32 v216, v216
  v_exp_f32 v217, v217
  v_exp_f32 v218, v218
  v_exp_f32 v219, v219
  v_exp_f32 v220, v220
  v_exp_f32 v221, v221
  v_exp_f32 v222, v222
  v_exp_f32 v223, v223
  v_pk_fma_f32 v[216:217], v[216:217], s[8:9], s[8:9]
  v_pk_fma_f32 v[218:219], v[218:219], s[8:9], s[8:9]
  v_pk_fma_f32 v[220:221], v[220:221], s[8:9], s[8:9]
  v_pk_fma_f32 v[222:223], v[222:223], s[8:9], s[8:9]
  v_rcp_f32 v216, v216
  v_rcp_f32 v217, v217
  v_rcp_f32 v218, v218
  v_rcp_f32 v219, v219
  v_rcp_f32 v220, v220
  v_rcp_f32 v221, v221
  v_rcp_f32 v222, v222
  v_rcp_f32 v223, v223
  v_pk_mul_f32 v[4:5], v[4:5], v[216:217]
  v_pk_mul_f32 v[6:7], v[6:7], v[218:219]
  v_pk_mul_f32 v[8:9], v[8:9], v[220:221]
  v_pk_mul_f32 v[10:11], v[10:11], v[222:223]
  v_cvt_pk_bf16_f32 v4, v4, v5
  v_cvt_pk_bf16_f32 v5, v6, v7
  v_cvt_pk_bf16_f32 v6, v8, v9
  v_cvt_pk_bf16_f32 v7, v10, v11
  v_pk_fma_f32 v[216:217], v[120:121], v[210:211], v[116:117] op_sel:[0,1,0] op_sel_hi:[1,1,1]
  v_pk_fma_f32 v[218:219], v[122:123], v[210:211], v[118:119] op_sel:[0,1,0] op_sel_hi:[1,1,1]
  v_pk_fma_f32 v[220:221], v[128:129], v[210:211], v[124:125] op_sel:[0,1,0] op_sel_hi:[1,1,1]
  v_pk_fma_f32 v[222:223], v[130:131], v[210:211], v[126:127] op_sel:[0,1,0] op_sel_hi:[1,1,1]
  v_pk_fma_f32 v[28:29], v[28:29], v[210:211], v[216:217] op_sel:[0,0,0] op_sel_hi:[1,0,1]
  v_pk_fma_f32 v[30:31], v[30:31], v[210:211], v[218:219] op_sel:[0,0,0] op_sel_hi:[1,0,1]
  v_pk_fma_f32 v[32:33], v[32:33], v[210:211], v[220:221] op_sel:[0,0,0] op_sel_hi:[1,0,1]
  v_pk_fma_f32 v[34:35], v[34:35], v[210:211], v[222:223] op_sel:[0,0,0] op_sel_hi:[1,0,1]
  v_pk_fma_f32 v[216:217], v[28:29], v[28:29], v[232:233]
  v_pk_fma_f32 v[218:219], v[30:31], v[30:31], v[232:233]
  v_pk_fma_f32 v[220:221], v[32:33], v[32:33], v[232:233]
  v_pk_fma_f32 v[222:223], v[34:35], v[34:35], v[232:233]
  v_pk_mul_f32 v[216:217], v[216:217], v[28:29]
  v_pk_mul_f32 v[218:219], v[218:219], v[30:31]
  v_pk_mul_f32 v[220:221], v[220:221], v[32:33]
  v_pk_mul_f32 v[222:223], v[222:223], v[34:35]
  v_exp_f32 v216, v216
  v_exp_f32 v217, v217
  v_exp_f32 v218, v218
  v_exp_f32 v219, v219
  v_exp_f32 v220, v220
  v_exp_f32 v221, v221
  v_exp_f32 v222, v222
  v_exp_f32 v223, v223
  v_pk_fma_f32 v[216:217], v[216:217], s[8:9], s[8:9]
  v_pk_fma_f32 v[218:219], v[218:219], s[8:9], s[8:9]
  v_pk_fma_f32 v[220:221], v[220:221], s[8:9], s[8:9]
  v_pk_fma_f32 v[222:223], v[222:223], s[8:9], s[8:9]
  v_rcp_f32 v216, v216
  v_rcp_f32 v217, v217
  v_rcp_f32 v218, v218
  v_rcp_f32 v219, v219
  v_rcp_f32 v220, v220
  v_rcp_f32 v221, v221
  v_rcp_f32 v222, v222
  v_rcp_f32 v223, v223
  v_permlane32_swap_b32 v4, v6
  v_permlane32_swap_b32 v5, v7
  buffer_store_dwordx4 v[4:7], v207, s[20:23], s4 offen offset:0 sc1
  ds_write_b128 v240, v[4:7] offset:0
  v_pk_mul_f32 v[28:29], v[28:29], v[216:217]
  v_pk_mul_f32 v[30:31], v[30:31], v[218:219]
  v_pk_mul_f32 v[32:33], v[32:33], v[220:221]
  v_pk_mul_f32 v[34:35], v[34:35], v[222:223]
  v_cvt_pk_bf16_f32 v28, v28, v29
  v_cvt_pk_bf16_f32 v29, v30, v31
  v_cvt_pk_bf16_f32 v30, v32, v33
  v_cvt_pk_bf16_f32 v31, v34, v35
  v_pk_fma_f32 v[216:217], v[120:121], v[212:213], v[116:117] op_sel:[0,1,0] op_sel_hi:[1,1,1]
  v_pk_fma_f32 v[218:219], v[122:123], v[212:213], v[118:119] op_sel:[0,1,0] op_sel_hi:[1,1,1]
  v_pk_fma_f32 v[220:221], v[128:129], v[212:213], v[124:125] op_sel:[0,1,0] op_sel_hi:[1,1,1]
  v_pk_fma_f32 v[222:223], v[130:131], v[212:213], v[126:127] op_sel:[0,1,0] op_sel_hi:[1,1,1]
  v_pk_fma_f32 v[52:53], v[52:53], v[212:213], v[216:217] op_sel:[0,0,0] op_sel_hi:[1,0,1]
  v_pk_fma_f32 v[54:55], v[54:55], v[212:213], v[218:219] op_sel:[0,0,0] op_sel_hi:[1,0,1]
  v_pk_fma_f32 v[56:57], v[56:57], v[212:213], v[220:221] op_sel:[0,0,0] op_sel_hi:[1,0,1]
  v_pk_fma_f32 v[58:59], v[58:59], v[212:213], v[222:223] op_sel:[0,0,0] op_sel_hi:[1,0,1]
  v_pk_fma_f32 v[216:217], v[52:53], v[52:53], v[232:233]
  v_pk_fma_f32 v[218:219], v[54:55], v[54:55], v[232:233]
  v_pk_fma_f32 v[220:221], v[56:57], v[56:57], v[232:233]
  v_pk_fma_f32 v[222:223], v[58:59], v[58:59], v[232:233]
  v_pk_mul_f32 v[216:217], v[216:217], v[52:53]
  v_pk_mul_f32 v[218:219], v[218:219], v[54:55]
  v_pk_mul_f32 v[220:221], v[220:221], v[56:57]
  v_pk_mul_f32 v[222:223], v[222:223], v[58:59]
  v_exp_f32 v216, v216
  v_exp_f32 v217, v217
  v_exp_f32 v218, v218
  v_exp_f32 v219, v219
  v_exp_f32 v220, v220
  v_exp_f32 v221, v221
  v_exp_f32 v222, v222
  v_exp_f32 v223, v223
  v_pk_fma_f32 v[216:217], v[216:217], s[8:9], s[8:9]
  v_pk_fma_f32 v[218:219], v[218:219], s[8:9], s[8:9]
  v_pk_fma_f32 v[220:221], v[220:221], s[8:9], s[8:9]
  v_pk_fma_f32 v[222:223], v[222:223], s[8:9], s[8:9]
  v_rcp_f32 v216, v216
  v_rcp_f32 v217, v217
  v_rcp_f32 v218, v218
  v_rcp_f32 v219, v219
  v_rcp_f32 v220, v220
  v_rcp_f32 v221, v221
  v_rcp_f32 v222, v222
  v_rcp_f32 v223, v223
  v_permlane32_swap_b32 v28, v30
  v_permlane32_swap_b32 v29, v31
  buffer_store_dwordx4 v[28:31], v207, s[20:23], s4 offen offset:256 sc1
  ds_write_b128 v240, v[28:31] offset:256
  v_pk_mul_f32 v[52:53], v[52:53], v[216:217]
  v_pk_mul_f32 v[54:55], v[54:55], v[218:219]
  v_pk_mul_f32 v[56:57], v[56:57], v[220:221]
  v_pk_mul_f32 v[58:59], v[58:59], v[222:223]
  v_cvt_pk_bf16_f32 v52, v52, v53
  v_cvt_pk_bf16_f32 v53, v54, v55
  v_cvt_pk_bf16_f32 v54, v56, v57
  v_cvt_pk_bf16_f32 v55, v58, v59
  v_pk_fma_f32 v[216:217], v[120:121], v[214:215], v[116:117] op_sel:[0,1,0] op_sel_hi:[1,1,1]
  v_pk_fma_f32 v[218:219], v[122:123], v[214:215], v[118:119] op_sel:[0,1,0] op_sel_hi:[1,1,1]
  v_pk_fma_f32 v[220:221], v[128:129], v[214:215], v[124:125] op_sel:[0,1,0] op_sel_hi:[1,1,1]
  v_pk_fma_f32 v[222:223], v[130:131], v[214:215], v[126:127] op_sel:[0,1,0] op_sel_hi:[1,1,1]
  v_pk_fma_f32 v[76:77], v[76:77], v[214:215], v[216:217] op_sel:[0,0,0] op_sel_hi:[1,0,1]
  v_pk_fma_f32 v[78:79], v[78:79], v[214:215], v[218:219] op_sel:[0,0,0] op_sel_hi:[1,0,1]
  v_pk_fma_f32 v[80:81], v[80:81], v[214:215], v[220:221] op_sel:[0,0,0] op_sel_hi:[1,0,1]
  v_pk_fma_f32 v[82:83], v[82:83], v[214:215], v[222:223] op_sel:[0,0,0] op_sel_hi:[1,0,1]
  v_pk_fma_f32 v[216:217], v[76:77], v[76:77], v[232:233]
  v_pk_fma_f32 v[218:219], v[78:79], v[78:79], v[232:233]
  v_pk_fma_f32 v[220:221], v[80:81], v[80:81], v[232:233]
  v_pk_fma_f32 v[222:223], v[82:83], v[82:83], v[232:233]
  v_pk_mul_f32 v[216:217], v[216:217], v[76:77]
  v_pk_mul_f32 v[218:219], v[218:219], v[78:79]
  v_pk_mul_f32 v[220:221], v[220:221], v[80:81]
  v_pk_mul_f32 v[222:223], v[222:223], v[82:83]
  v_exp_f32 v216, v216
  v_exp_f32 v217, v217
  v_exp_f32 v218, v218
  v_exp_f32 v219, v219
  v_exp_f32 v220, v220
  v_exp_f32 v221, v221
  v_exp_f32 v222, v222
  v_exp_f32 v223, v223
  v_pk_fma_f32 v[216:217], v[216:217], s[8:9], s[8:9]
  v_pk_fma_f32 v[218:219], v[218:219], s[8:9], s[8:9]
  v_pk_fma_f32 v[220:221], v[220:221], s[8:9], s[8:9]
  v_pk_fma_f32 v[222:223], v[222:223], s[8:9], s[8:9]
  v_rcp_f32 v216, v216
  v_rcp_f32 v217, v217
  v_rcp_f32 v218, v218
  v_rcp_f32 v219, v219
  v_rcp_f32 v220, v220
  v_rcp_f32 v221, v221
  v_rcp_f32 v222, v222
  v_rcp_f32 v223, v223
  v_permlane32_swap_b32 v52, v54
  v_permlane32_swap_b32 v53, v55
  buffer_store_dwordx4 v[52:55], v207, s[20:23], s5 offen offset:0 sc1
  ds_write_b128 v240, v[52:55] offset:4096
  v_pk_mul_f32 v[76:77], v[76:77], v[216:217]
  v_pk_mul_f32 v[78:79], v[78:79], v[218:219]
  v_pk_mul_f32 v[80:81], v[80:81], v[220:221]
  v_pk_mul_f32 v[82:83], v[82:83], v[222:223]
  v_cvt_pk_bf16_f32 v76, v76, v77
  v_cvt_pk_bf16_f32 v77, v78, v79
  v_cvt_pk_bf16_f32 v78, v80, v81
  v_cvt_pk_bf16_f32 v79, v82, v83
  ds_read_b128 v[116:119], v234 offset:256
  ds_read_b128 v[120:123], v234 offset:1280
  ds_read_b128 v[124:127], v234 offset:288
  ds_read_b128 v[128:131], v234 offset:1312
  s_add_u32 s6, s4, 4096
  s_add_u32 s7, s5, 4096
  v_pk_fma_f32 v[216:217], v[136:137], v[208:209], v[132:133] op_sel:[0,1,0] op_sel_hi:[1,1,1]
  v_pk_fma_f32 v[218:219], v[138:139], v[208:209], v[134:135] op_sel:[0,1,0] op_sel_hi:[1,1,1]
  v_pk_fma_f32 v[220:221], v[144:145], v[208:209], v[140:141] op_sel:[0,1,0] op_sel_hi:[1,1,1]
  v_pk_fma_f32 v[222:223], v[146:147], v[208:209], v[142:143] op_sel:[0,1,0] op_sel_hi:[1,1,1]
  v_pk_fma_f32 v[12:13], v[12:13], v[208:209], v[216:217] op_sel:[0,0,0] op_sel_hi:[1,0,1]
  v_pk_fma_f32 v[14:15], v[14:15], v[208:209], v[218:219] op_sel:[0,0,0] op_sel_hi:[1,0,1]
  v_pk_fma_f32 v[16:17], v[16:17], v[208:209], v[220:221] op_sel:[0,0,0] op_sel_hi:[1,0,1]
  v_pk_fma_f32 v[18:19], v[18:19], v[208:209], v[222:223] op_sel:[0,0,0] op_sel_hi:[1,0,1]
  v_pk_fma_f32 v[216:217], v[12:13], v[12:13], v[232:233]
  v_pk_fma_f32 v[218:219], v[14:15], v[14:15], v[232:233]
  v_pk_fma_f32 v[220:221], v[16:17], v[16:17], v[232:233]
  v_pk_fma_f32 v[222:223], v[18:19], v[18:19], v[232:233]
  v_pk_mul_f32 v[216:217], v[216:217], v[12:13]
  v_pk_mul_f32 v[218:219], v[218:219], v[14:15]
  v_pk_mul_f32 v[220:221], v[220:221], v[16:17]
  v_pk_mul_f32 v[222:223], v[222:223], v[18:19]
  v_exp_f32 v216, v216
  v_exp_f32 v217, v217
  v_exp_f32 v218, v218
  v_exp_f32 v219, v219
  v_exp_f32 v220, v220
  v_exp_f32 v221, v221
  v_exp_f32 v222, v222
  v_exp_f32 v223, v223
  v_pk_fma_f32 v[216:217], v[216:217], s[8:9], s[8:9]
  v_pk_fma_f32 v[218:219], v[218:219], s[8:9], s[8:9]
  v_pk_fma_f32 v[220:221], v[220:221], s[8:9], s[8:9]
  v_pk_fma_f32 v[222:223], v[222:223], s[8:9], s[8:9]
  v_rcp_f32 v216, v216
  v_rcp_f32 v217, v217
  v_rcp_f32 v218, v218
  v_rcp_f32 v219, v219
  v_rcp_f32 v220, v220
  v_rcp_f32 v221, v221
  v_rcp_f32 v222, v222
  v_rcp_f32 v223, v223
  v_permlane32_swap_b32 v76, v78
  v_permlane32_swap_b32 v77, v79
  buffer_store_dwordx4 v[76:79], v207, s[20:23], s5 offen offset:256 sc1
  ds_write_b128 v240, v[76:79] offset:4352
  v_pk_mul_f32 v[12:13], v[12:13], v[216:217]
  v_pk_mul_f32 v[14:15], v[14:15], v[218:219]
  v_pk_mul_f32 v[16:17], v[16:17], v[220:221]
  v_pk_mul_f32 v[18:19], v[18:19], v[222:223]
  v_cvt_pk_bf16_f32 v12, v12, v13
  v_cvt_pk_bf16_f32 v13, v14, v15
  v_cvt_pk_bf16_f32 v14, v16, v17
  v_cvt_pk_bf16_f32 v15, v18, v19
  v_pk_fma_f32 v[216:217], v[136:137], v[210:211], v[132:133] op_sel:[0,1,0] op_sel_hi:[1,1,1]
  v_pk_fma_f32 v[218:219], v[138:139], v[210:211], v[134:135] op_sel:[0,1,0] op_sel_hi:[1,1,1]
  v_pk_fma_f32 v[220:221], v[144:145], v[210:211], v[140:141] op_sel:[0,1,0] op_sel_hi:[1,1,1]
  v_pk_fma_f32 v[222:223], v[146:147], v[210:211], v[142:143] op_sel:[0,1,0] op_sel_hi:[1,1,1]
  v_pk_fma_f32 v[36:37], v[36:37], v[210:211], v[216:217] op_sel:[0,0,0] op_sel_hi:[1,0,1]
  v_pk_fma_f32 v[38:39], v[38:39], v[210:211], v[218:219] op_sel:[0,0,0] op_sel_hi:[1,0,1]
  v_pk_fma_f32 v[40:41], v[40:41], v[210:211], v[220:221] op_sel:[0,0,0] op_sel_hi:[1,0,1]
  v_pk_fma_f32 v[42:43], v[42:43], v[210:211], v[222:223] op_sel:[0,0,0] op_sel_hi:[1,0,1]
  v_pk_fma_f32 v[216:217], v[36:37], v[36:37], v[232:233]
  v_pk_fma_f32 v[218:219], v[38:39], v[38:39], v[232:233]
  v_pk_fma_f32 v[220:221], v[40:41], v[40:41], v[232:233]
  v_pk_fma_f32 v[222:223], v[42:43], v[42:43], v[232:233]
  v_pk_mul_f32 v[216:217], v[216:217], v[36:37]
  v_pk_mul_f32 v[218:219], v[218:219], v[38:39]
  v_pk_mul_f32 v[220:221], v[220:221], v[40:41]
  v_pk_mul_f32 v[222:223], v[222:223], v[42:43]
  v_exp_f32 v216, v216
  v_exp_f32 v217, v217
  v_exp_f32 v218, v218
  v_exp_f32 v219, v219
  v_exp_f32 v220, v220
  v_exp_f32 v221, v221
  v_exp_f32 v222, v222
  v_exp_f32 v223, v223
  v_pk_fma_f32 v[216:217], v[216:217], s[8:9], s[8:9]
  v_pk_fma_f32 v[218:219], v[218:219], s[8:9], s[8:9]
  v_pk_fma_f32 v[220:221], v[220:221], s[8:9], s[8:9]
  v_pk_fma_f32 v[222:223], v[222:223], s[8:9], s[8:9]
  v_rcp_f32 v216, v216
  v_rcp_f32 v217, v217
  v_rcp_f32 v218, v218
  v_rcp_f32 v219, v219
  v_rcp_f32 v220, v220
  v_rcp_f32 v221, v221
  v_rcp_f32 v222, v222
  v_rcp_f32 v223, v223
  v_permlane32_swap_b32 v12, v14
  v_permlane32_swap_b32 v13, v15
  buffer_store_dwordx4 v[12:15], v207, s[20:23], s4 offen offset:2048 sc1
  ds_write_b128 v240, v[12:15] offset:2048
  v_pk_mul_f32 v[36:37], v[36:37], v[216:217]
  v_pk_mul_f32 v[38:39], v[38:39], v[218:219]
  v_pk_mul_f32 v[40:41], v[40:41], v[220:221]
  v_pk_mul_f32 v[42:43], v[42:43], v[222:223]
  v_cvt_pk_bf16_f32 v36, v36, v37
  v_cvt_pk_bf16_f32 v37, v38, v39
  v_cvt_pk_bf16_f32 v38, v40, v41
  v_cvt_pk_bf16_f32 v39, v42, v43
  v_pk_fma_f32 v[216:217], v[136:137], v[212:213], v[132:133] op_sel:[0,1,0] op_sel_hi:[1,1,1]
  v_pk_fma_f32 v[218:219], v[138:139], v[212:213], v[134:135] op_sel:[0,1,0] op_sel_hi:[1,1,1]
  v_pk_fma_f32 v[220:221], v[144:145], v[212:213], v[140:141] op_sel:[0,1,0] op_sel_hi:[1,1,1]
  v_pk_fma_f32 v[222:223], v[146:147], v[212:213], v[142:143] op_sel:[0,1,0] op_sel_hi:[1,1,1]
  v_pk_fma_f32 v[60:61], v[60:61], v[212:213], v[216:217] op_sel:[0,0,0] op_sel_hi:[1,0,1]
  v_pk_fma_f32 v[62:63], v[62:63], v[212:213], v[218:219] op_sel:[0,0,0] op_sel_hi:[1,0,1]
  v_pk_fma_f32 v[64:65], v[64:65], v[212:213], v[220:221] op_sel:[0,0,0] op_sel_hi:[1,0,1]
  v_pk_fma_f32 v[66:67], v[66:67], v[212:213], v[222:223] op_sel:[0,0,0] op_sel_hi:[1,0,1]
  v_pk_fma_f32 v[216:217], v[60:61], v[60:61], v[232:233]
  v_pk_fma_f32 v[218:219], v[62:63], v[62:63], v[232:233]
  v_pk_fma_f32 v[220:221], v[64:65], v[64:65], v[232:233]
  v_pk_fma_f32 v[222:223], v[66:67], v[66:67], v[232:233]
  v_pk_mul_f32 v[216:217], v[216:217], v[60:61]
  v_pk_mul_f32 v[218:219], v[218:219], v[62:63]
  v_pk_mul_f32 v[220:221], v[220:221], v[64:65]
  v_pk_mul_f32 v[222:223], v[222:223], v[66:67]
  v_exp_f32 v216, v216
  v_exp_f32 v217, v217
  v_exp_f32 v218, v218
  v_exp_f32 v219, v219
  v_exp_f32 v220, v220
  v_exp_f32 v221, v221
  v_exp_f32 v222, v222
  v_exp_f32 v223, v223
  v_pk_fma_f32 v[216:217], v[216:217], s[8:9], s[8:9]
  v_pk_fma_f32 v[218:219], v[218:219], s[8:9], s[8:9]
  v_pk_fma_f32 v[220:221], v[220:221], s[8:9], s[8:9]
  v_pk_fma_f32 v[222:223], v[222:223], s[8:9], s[8:9]
  v_rcp_f32 v216, v216
  v_rcp_f32 v217, v217
  v_rcp_f32 v218, v218
  v_rcp_f32 v219, v219
  v_rcp_f32 v220, v220
  v_rcp_f32 v221, v221
  v_rcp_f32 v222, v222
  v_rcp_f32 v223, v223
  v_permlane32_swap_b32 v36, v38
  v_permlane32_swap_b32 v37, v39
  buffer_store_dwordx4 v[36:39], v207, s[20:23], s4 offen offset:2304 sc1
  ds_write_b128 v240, v[36:39] offset:2304
  v_pk_mul_f32 v[60:61], v[60:61], v[216:217]
  v_pk_mul_f32 v[62:63], v[62:63], v[218:219]
  v_pk_mul_f32 v[64:65], v[64:65], v[220:221]
  v_pk_mul_f32 v[66:67], v[66:67], v[222:223]
  v_cvt_pk_bf16_f32 v60, v60, v61
  v_cvt_pk_bf16_f32 v61, v62, v63
  v_cvt_pk_bf16_f32 v62, v64, v65
  v_cvt_pk_bf16_f32 v63, v66, v67
  v_pk_fma_f32 v[216:217], v[136:137], v[214:215], v[132:133] op_sel:[0,1,0] op_sel_hi:[1,1,1]
  v_pk_fma_f32 v[218:219], v[138:139], v[214:215], v[134:135] op_sel:[0,1,0] op_sel_hi:[1,1,1]
  v_pk_fma_f32 v[220:221], v[144:145], v[214:215], v[140:141] op_sel:[0,1,0] op_sel_hi:[1,1,1]
  v_pk_fma_f32 v[222:223], v[146:147], v[214:215], v[142:143] op_sel:[0,1,0] op_sel_hi:[1,1,1]
  v_pk_fma_f32 v[84:85], v[84:85], v[214:215], v[216:217] op_sel:[0,0,0] op_sel_hi:[1,0,1]
  v_pk_fma_f32 v[86:87], v[86:87], v[214:215], v[218:219] op_sel:[0,0,0] op_sel_hi:[1,0,1]
  v_pk_fma_f32 v[88:89], v[88:89], v[214:215], v[220:221] op_sel:[0,0,0] op_sel_hi:[1,0,1]
  v_pk_fma_f32 v[90:91], v[90:91], v[214:215], v[222:223] op_sel:[0,0,0] op_sel_hi:[1,0,1]
  v_pk_fma_f32 v[216:217], v[84:85], v[84:85], v[232:233]
  v_pk_fma_f32 v[218:219], v[86:87], v[86:87], v[232:233]
  v_pk_fma_f32 v[220:221], v[88:89], v[88:89], v[232:233]
  v_pk_fma_f32 v[222:223], v[90:91], v[90:91], v[232:233]
  v_pk_mul_f32 v[216:217], v[216:217], v[84:85]
  v_pk_mul_f32 v[218:219], v[218:219], v[86:87]
  v_pk_mul_f32 v[220:221], v[220:221], v[88:89]
  v_pk_mul_f32 v[222:223], v[222:223], v[90:91]
  v_exp_f32 v216, v216
  v_exp_f32 v217, v217
  v_exp_f32 v218, v218
  v_exp_f32 v219, v219
  v_exp_f32 v220, v220
  v_exp_f32 v221, v221
  v_exp_f32 v222, v222
  v_exp_f32 v223, v223
  v_pk_fma_f32 v[216:217], v[216:217], s[8:9], s[8:9]
  v_pk_fma_f32 v[218:219], v[218:219], s[8:9], s[8:9]
  v_pk_fma_f32 v[220:221], v[220:221], s[8:9], s[8:9]
  v_pk_fma_f32 v[222:223], v[222:223], s[8:9], s[8:9]
  v_rcp_f32 v216, v216
  v_rcp_f32 v217, v217
  v_rcp_f32 v218, v218
  v_rcp_f32 v219, v219
  v_rcp_f32 v220, v220
  v_rcp_f32 v221, v221
  v_rcp_f32 v222, v222
  v_rcp_f32 v223, v223
  v_permlane32_swap_b32 v60, v62
  v_permlane32_swap_b32 v61, v63
  buffer_store_dwordx4 v[60:63], v207, s[20:23], s5 offen offset:2048 sc1
  ds_write_b128 v240, v[60:63] offset:6144
  v_pk_mul_f32 v[84:85], v[84:85], v[216:217]
  v_pk_mul_f32 v[86:87], v[86:87], v[218:219]
  v_pk_mul_f32 v[88:89], v[88:89], v[220:221]
  v_pk_mul_f32 v[90:91], v[90:91], v[222:223]
  v_cvt_pk_bf16_f32 v84, v84, v85
  v_cvt_pk_bf16_f32 v85, v86, v87
  v_cvt_pk_bf16_f32 v86, v88, v89
  v_cvt_pk_bf16_f32 v87, v90, v91
  s_waitcnt lgkmcnt(0)
  v_pk_fma_f32 v[216:217], v[120:121], v[208:209], v[116:117] op_sel:[0,1,0] op_sel_hi:[1,1,1]
  v_pk_fma_f32 v[218:219], v[122:123], v[208:209], v[118:119] op_sel:[0,1,0] op_sel_hi:[1,1,1]
  v_pk_fma_f32 v[220:221], v[128:129], v[208:209], v[124:125] op_sel:[0,1,0] op_sel_hi:[1,1,1]
  v_pk_fma_f32 v[222:223], v[130:131], v[208:209], v[126:127] op_sel:[0,1,0] op_sel_hi:[1,1,1]
  v_pk_fma_f32 v[20:21], v[20:21], v[208:209], v[216:217] op_sel:[0,0,0] op_sel_hi:[1,0,1]
  v_pk_fma_f32 v[22:23], v[22:23], v[208:209], v[218:219] op_sel:[0,0,0] op_sel_hi:[1,0,1]
  v_pk_fma_f32 v[24:25], v[24:25], v[208:209], v[220:221] op_sel:[0,0,0] op_sel_hi:[1,0,1]
  v_pk_fma_f32 v[26:27], v[26:27], v[208:209], v[222:223] op_sel:[0,0,0] op_sel_hi:[1,0,1]
  v_pk_fma_f32 v[216:217], v[20:21], v[20:21], v[232:233]
  v_pk_fma_f32 v[218:219], v[22:23], v[22:23], v[232:233]
  v_pk_fma_f32 v[220:221], v[24:25], v[24:25], v[232:233]
  v_pk_fma_f32 v[222:223], v[26:27], v[26:27], v[232:233]
  v_pk_mul_f32 v[216:217], v[216:217], v[20:21]
  v_pk_mul_f32 v[218:219], v[218:219], v[22:23]
  v_pk_mul_f32 v[220:221], v[220:221], v[24:25]
  v_pk_mul_f32 v[222:223], v[222:223], v[26:27]
  v_exp_f32 v216, v216
  v_exp_f32 v217, v217
  v_exp_f32 v218, v218
  v_exp_f32 v219, v219
  v_exp_f32 v220, v220
  v_exp_f32 v221, v221
  v_exp_f32 v222, v222
  v_exp_f32 v223, v223
  v_pk_fma_f32 v[216:217], v[216:217], s[8:9], s[8:9]
  v_pk_fma_f32 v[218:219], v[218:219], s[8:9], s[8:9]
  v_pk_fma_f32 v[220:221], v[220:221], s[8:9], s[8:9]
  v_pk_fma_f32 v[222:223], v[222:223], s[8:9], s[8:9]
  v_rcp_f32 v216, v216
  v_rcp_f32 v217, v217
  v_rcp_f32 v218, v218
  v_rcp_f32 v219, v219
  v_rcp_f32 v220, v220
  v_rcp_f32 v221, v221
  v_rcp_f32 v222, v222
  v_rcp_f32 v223, v223
  v_permlane32_swap_b32 v84, v86
  v_permlane32_swap_b32 v85, v87
  buffer_store_dwordx4 v[84:87], v207, s[20:23], s5 offen offset:2304 sc1
  ds_write_b128 v240, v[84:87] offset:6400
  v_pk_mul_f32 v[20:21], v[20:21], v[216:217]
  v_pk_mul_f32 v[22:23], v[22:23], v[218:219]
  v_pk_mul_f32 v[24:25], v[24:25], v[220:221]
  v_pk_mul_f32 v[26:27], v[26:27], v[222:223]
  v_cvt_pk_bf16_f32 v20, v20, v21
  v_cvt_pk_bf16_f32 v21, v22, v23
  v_cvt_pk_bf16_f32 v22, v24, v25
  v_cvt_pk_bf16_f32 v23, v26, v27
  v_pk_fma_f32 v[216:217], v[120:121], v[210:211], v[116:117] op_sel:[0,1,0] op_sel_hi:[1,1,1]
  v_pk_fma_f32 v[218:219], v[122:123], v[210:211], v[118:119] op_sel:[0,1,0] op_sel_hi:[1,1,1]
  v_pk_fma_f32 v[220:221], v[128:129], v[210:211], v[124:125] op_sel:[0,1,0] op_sel_hi:[1,1,1]
  v_pk_fma_f32 v[222:223], v[130:131], v[210:211], v[126:127] op_sel:[0,1,0] op_sel_hi:[1,1,1]
  v_pk_fma_f32 v[44:45], v[44:45], v[210:211], v[216:217] op_sel:[0,0,0] op_sel_hi:[1,0,1]
  v_pk_fma_f32 v[46:47], v[46:47], v[210:211], v[218:219] op_sel:[0,0,0] op_sel_hi:[1,0,1]
  v_pk_fma_f32 v[48:49], v[48:49], v[210:211], v[220:221] op_sel:[0,0,0] op_sel_hi:[1,0,1]
  v_pk_fma_f32 v[50:51], v[50:51], v[210:211], v[222:223] op_sel:[0,0,0] op_sel_hi:[1,0,1]
  v_pk_fma_f32 v[216:217], v[44:45], v[44:45], v[232:233]
  v_pk_fma_f32 v[218:219], v[46:47], v[46:47], v[232:233]
  v_pk_fma_f32 v[220:221], v[48:49], v[48:49], v[232:233]
  v_pk_fma_f32 v[222:223], v[50:51], v[50:51], v[232:233]
  v_pk_mul_f32 v[216:217], v[216:217], v[44:45]
  v_pk_mul_f32 v[218:219], v[218:219], v[46:47]
  v_pk_mul_f32 v[220:221], v[220:221], v[48:49]
  v_pk_mul_f32 v[222:223], v[222:223], v[50:51]
  v_exp_f32 v216, v216
  v_exp_f32 v217, v217
  v_exp_f32 v218, v218
  v_exp_f32 v219, v219
  v_exp_f32 v220, v220
  v_exp_f32 v221, v221
  v_exp_f32 v222, v222
  v_exp_f32 v223, v223
  v_pk_fma_f32 v[216:217], v[216:217], s[8:9], s[8:9]
  v_pk_fma_f32 v[218:219], v[218:219], s[8:9], s[8:9]
  v_pk_fma_f32 v[220:221], v[220:221], s[8:9], s[8:9]
  v_pk_fma_f32 v[222:223], v[222:223], s[8:9], s[8:9]
  v_rcp_f32 v216, v216
  v_rcp_f32 v217, v217
  v_rcp_f32 v218, v218
  v_rcp_f32 v219, v219
  v_rcp_f32 v220, v220
  v_rcp_f32 v221, v221
  v_rcp_f32 v222, v222
  v_rcp_f32 v223, v223
  v_permlane32_swap_b32 v20, v22
  v_permlane32_swap_b32 v21, v23
  buffer_store_dwordx4 v[20:23], v207, s[20:23], s6 offen offset:0 sc1
  ds_write_b128 v240, v[20:23] offset:32768
  v_pk_mul_f32 v[44:45], v[44:45], v[216:217]
  v_pk_mul_f32 v[46:47], v[46:47], v[218:219]
  v_pk_mul_f32 v[48:49], v[48:49], v[220:221]
  v_pk_mul_f32 v[50:51], v[50:51], v[222:223]
  v_cvt_pk_bf16_f32 v44, v44, v45
  v_cvt_pk_bf16_f32 v45, v46, v47
  v_cvt_pk_bf16_f32 v46, v48, v49
  v_cvt_pk_bf16_f32 v47, v50, v51
  v_pk_fma_f32 v[216:217], v[120:121], v[212:213], v[116:117] op_sel:[0,1,0] op_sel_hi:[1,1,1]
  v_pk_fma_f32 v[218:219], v[122:123], v[212:213], v[118:119] op_sel:[0,1,0] op_sel_hi:[1,1,1]
  v_pk_fma_f32 v[220:221], v[128:129], v[212:213], v[124:125] op_sel:[0,1,0] op_sel_hi:[1,1,1]
  v_pk_fma_f32 v[222:223], v[130:131], v[212:213], v[126:127] op_sel:[0,1,0] op_sel_hi:[1,1,1]
  v_pk_fma_f32 v[68:69], v[68:69], v[212:213], v[216:217] op_sel:[0,0,0] op_sel_hi:[1,0,1]
  v_pk_fma_f32 v[70:71], v[70:71], v[212:213], v[218:219] op_sel:[0,0,0] op_sel_hi:[1,0,1]
  v_pk_fma_f32 v[72:73], v[72:73], v[212:213], v[220:221] op_sel:[0,0,0] op_sel_hi:[1,0,1]
  v_pk_fma_f32 v[74:75], v[74:75], v[212:213], v[222:223] op_sel:[0,0,0] op_sel_hi:[1,0,1]
  v_pk_fma_f32 v[216:217], v[68:69], v[68:69], v[232:233]
  v_pk_fma_f32 v[218:219], v[70:71], v[70:71], v[232:233]
  v_pk_fma_f32 v[220:221], v[72:73], v[72:73], v[232:233]
  v_pk_fma_f32 v[222:223], v[74:75], v[74:75], v[232:233]
  v_pk_mul_f32 v[216:217], v[216:217], v[68:69]
  v_pk_mul_f32 v[218:219], v[218:219], v[70:71]
  v_pk_mul_f32 v[220:221], v[220:221], v[72:73]
  v_pk_mul_f32 v[222:223], v[222:223], v[74:75]
  v_exp_f32 v216, v216
  v_exp_f32 v217, v217
  v_exp_f32 v218, v218
  v_exp_f32 v219, v219
  v_exp_f32 v220, v220
  v_exp_f32 v221, v221
  v_exp_f32 v222, v222
  v_exp_f32 v223, v223
  v_pk_fma_f32 v[216:217], v[216:217], s[8:9], s[8:9]
  v_pk_fma_f32 v[218:219], v[218:219], s[8:9], s[8:9]
  v_pk_fma_f32 v[220:221], v[220:221], s[8:9], s[8:9]
  v_pk_fma_f32 v[222:223], v[222:223], s[8:9], s[8:9]
  v_rcp_f32 v216, v216
  v_rcp_f32 v217, v217
  v_rcp_f32 v218, v218
  v_rcp_f32 v219, v219
  v_rcp_f32 v220, v220
  v_rcp_f32 v221, v221
  v_rcp_f32 v222, v222
  v_rcp_f32 v223, v223
  v_permlane32_swap_b32 v44, v46
  v_permlane32_swap_b32 v45, v47
  buffer_store_dwordx4 v[44:47], v207, s[20:23], s6 offen offset:256 sc1
  ds_write_b128 v240, v[44:47] offset:33024
  v_pk_mul_f32 v[68:69], v[68:69], v[216:217]
  v_pk_mul_f32 v[70:71], v[70:71], v[218:219]
  v_pk_mul_f32 v[72:73], v[72:73], v[220:221]
  v_pk_mul_f32 v[74:75], v[74:75], v[222:223]
  v_cvt_pk_bf16_f32 v68, v68, v69
  v_cvt_pk_bf16_f32 v69, v70, v71
  v_cvt_pk_bf16_f32 v70, v72, v73
  v_cvt_pk_bf16_f32 v71, v74, v75
  v_pk_fma_f32 v[216:217], v[120:121], v[214:215], v[116:117] op_sel:[0,1,0] op_sel_hi:[1,1,1]
  v_pk_fma_f32 v[218:219], v[122:123], v[214:215], v[118:119] op_sel:[0,1,0] op_sel_hi:[1,1,1]
  v_pk_fma_f32 v[220:221], v[128:129], v[214:215], v[124:125] op_sel:[0,1,0] op_sel_hi:[1,1,1]
  v_pk_fma_f32 v[222:223], v[130:131], v[214:215], v[126:127] op_sel:[0,1,0] op_sel_hi:[1,1,1]
  v_pk_fma_f32 v[92:93], v[92:93], v[214:215], v[216:217] op_sel:[0,0,0] op_sel_hi:[1,0,1]
  v_pk_fma_f32 v[94:95], v[94:95], v[214:215], v[218:219] op_sel:[0,0,0] op_sel_hi:[1,0,1]
  v_pk_fma_f32 v[96:97], v[96:97], v[214:215], v[220:221] op_sel:[0,0,0] op_sel_hi:[1,0,1]
  v_pk_fma_f32 v[98:99], v[98:99], v[214:215], v[222:223] op_sel:[0,0,0] op_sel_hi:[1,0,1]
  v_pk_fma_f32 v[216:217], v[92:93], v[92:93], v[232:233]
  v_pk_fma_f32 v[218:219], v[94:95], v[94:95], v[232:233]
  v_pk_fma_f32 v[220:221], v[96:97], v[96:97], v[232:233]
  v_pk_fma_f32 v[222:223], v[98:99], v[98:99], v[232:233]
  v_pk_mul_f32 v[216:217], v[216:217], v[92:93]
  v_pk_mul_f32 v[218:219], v[218:219], v[94:95]
  v_pk_mul_f32 v[220:221], v[220:221], v[96:97]
  v_pk_mul_f32 v[222:223], v[222:223], v[98:99]
  v_exp_f32 v216, v216
  v_exp_f32 v217, v217
  v_exp_f32 v218, v218
  v_exp_f32 v219, v219
  v_exp_f32 v220, v220
  v_exp_f32 v221, v221
  v_exp_f32 v222, v222
  v_exp_f32 v223, v223
  v_pk_fma_f32 v[216:217], v[216:217], s[8:9], s[8:9]
  v_pk_fma_f32 v[218:219], v[218:219], s[8:9], s[8:9]
  v_pk_fma_f32 v[220:221], v[220:221], s[8:9], s[8:9]
  v_pk_fma_f32 v[222:223], v[222:223], s[8:9], s[8:9]
  v_rcp_f32 v216, v216
  v_rcp_f32 v217, v217
  v_rcp_f32 v218, v218
  v_rcp_f32 v219, v219
  v_rcp_f32 v220, v220
  v_rcp_f32 v221, v221
  v_rcp_f32 v222, v222
  v_rcp_f32 v223, v223
  v_permlane32_swap_b32 v68, v70
  v_permlane32_swap_b32 v69, v71
  buffer_store_dwordx4 v[68:71], v207, s[20:23], s7 offen offset:0 sc1
  ds_write_b128 v240, v[68:71] offset:36864
  v_pk_mul_f32 v[92:93], v[92:93], v[216:217]
  v_pk_mul_f32 v[94:95], v[94:95], v[218:219]
  v_pk_mul_f32 v[96:97], v[96:97], v[220:221]
  v_pk_mul_f32 v[98:99], v[98:99], v[222:223]
  v_cvt_pk_bf16_f32 v92, v92, v93
  v_cvt_pk_bf16_f32 v93, v94, v95
  v_cvt_pk_bf16_f32 v94, v96, v97
  v_cvt_pk_bf16_f32 v95, v98, v99
  v_pk_fma_f32 v[216:217], v[152:153], v[208:209], v[148:149] op_sel:[0,1,0] op_sel_hi:[1,1,1]
  v_pk_fma_f32 v[218:219], v[154:155], v[208:209], v[150:151] op_sel:[0,1,0] op_sel_hi:[1,1,1]
  v_pk_fma_f32 v[220:221], v[152:153], v[210:211], v[148:149] op_sel:[0,1,0] op_sel_hi:[1,1,1]
  v_pk_fma_f32 v[222:223], v[154:155], v[210:211], v[150:151] op_sel:[0,1,0] op_sel_hi:[1,1,1]
  v_pk_fma_f32 v[100:101], v[100:101], v[208:209], v[216:217] op_sel:[0,0,0] op_sel_hi:[1,0,1]
  v_pk_fma_f32 v[102:103], v[102:103], v[208:209], v[218:219] op_sel:[0,0,0] op_sel_hi:[1,0,1]
  v_pk_fma_f32 v[104:105], v[104:105], v[210:211], v[220:221] op_sel:[0,0,0] op_sel_hi:[1,0,1]
  v_pk_fma_f32 v[106:107], v[106:107], v[210:211], v[222:223] op_sel:[0,0,0] op_sel_hi:[1,0,1]
  v_pk_fma_f32 v[216:217], v[100:101], v[100:101], v[232:233]
  v_pk_fma_f32 v[218:219], v[102:103], v[102:103], v[232:233]
  v_pk_fma_f32 v[220:221], v[104:105], v[104:105], v[232:233]
  v_pk_fma_f32 v[222:223], v[106:107], v[106:107], v[232:233]
  v_pk_mul_f32 v[216:217], v[216:217], v[100:101]
  v_pk_mul_f32 v[218:219], v[218:219], v[102:103]
  v_pk_mul_f32 v[220:221], v[220:221], v[104:105]
  v_pk_mul_f32 v[222:223], v[222:223], v[106:107]
  v_exp_f32 v216, v216
  v_exp_f32 v217, v217
  v_exp_f32 v218, v218
  v_exp_f32 v219, v219
  v_exp_f32 v220, v220
  v_exp_f32 v221, v221
  v_exp_f32 v222, v222
  v_exp_f32 v223, v223
  v_pk_fma_f32 v[216:217], v[216:217], s[8:9], s[8:9]
  v_pk_fma_f32 v[218:219], v[218:219], s[8:9], s[8:9]
  v_pk_fma_f32 v[220:221], v[220:221], s[8:9], s[8:9]
  v_pk_fma_f32 v[222:223], v[222:223], s[8:9], s[8:9]
  v_rcp_f32 v216, v216
  v_rcp_f32 v217, v217
  v_rcp_f32 v218, v218
  v_rcp_f32 v219, v219
  v_rcp_f32 v220, v220
  v_rcp_f32 v221, v221
  v_rcp_f32 v222, v222
  v_rcp_f32 v223, v223
  v_permlane32_swap_b32 v92, v94
  v_permlane32_swap_b32 v93, v95
  buffer_store_dwordx4 v[92:95], v207, s[20:23], s7 offen offset:256 sc1
  ds_write_b128 v240, v[92:95] offset:37120
  v_pk_mul_f32 v[100:101], v[100:101], v[216:217]
  v_pk_mul_f32 v[102:103], v[102:103], v[218:219]
  v_pk_mul_f32 v[104:105], v[104:105], v[220:221]
  v_pk_mul_f32 v[106:107], v[106:107], v[222:223]
  v_cvt_pk_bf16_f32 v100, v100, v101
  v_cvt_pk_bf16_f32 v101, v102, v103
  v_cvt_pk_bf16_f32 v102, v104, v105
  v_cvt_pk_bf16_f32 v103, v106, v107
  v_pk_fma_f32 v[216:217], v[152:153], v[212:213], v[148:149] op_sel:[0,1,0] op_sel_hi:[1,1,1]
  v_pk_fma_f32 v[218:219], v[154:155], v[212:213], v[150:151] op_sel:[0,1,0] op_sel_hi:[1,1,1]
  v_pk_fma_f32 v[220:221], v[152:153], v[214:215], v[148:149] op_sel:[0,1,0] op_sel_hi:[1,1,1]
  v_pk_fma_f32 v[222:223], v[154:155], v[214:215], v[150:151] op_sel:[0,1,0] op_sel_hi:[1,1,1]
  v_pk_fma_f32 v[108:109], v[108:109], v[212:213], v[216:217] op_sel:[0,0,0] op_sel_hi:[1,0,1]
  v_pk_fma_f32 v[110:111], v[110:111], v[212:213], v[218:219] op_sel:[0,0,0] op_sel_hi:[1,0,1]
  v_pk_fma_f32 v[112:113], v[112:113], v[214:215], v[220:221] op_sel:[0,0,0] op_sel_hi:[1,0,1]
  v_pk_fma_f32 v[114:115], v[114:115], v[214:215], v[222:223] op_sel:[0,0,0] op_sel_hi:[1,0,1]
  v_pk_fma_f32 v[216:217], v[108:109], v[108:109], v[232:233]
  v_pk_fma_f32 v[218:219], v[110:111], v[110:111], v[232:233]
  v_pk_fma_f32 v[220:221], v[112:113], v[112:113], v[232:233]
  v_pk_fma_f32 v[222:223], v[114:115], v[114:115], v[232:233]
  v_pk_mul_f32 v[216:217], v[216:217], v[108:109]
  v_pk_mul_f32 v[218:219], v[218:219], v[110:111]
  v_pk_mul_f32 v[220:221], v[220:221], v[112:113]
  v_pk_mul_f32 v[222:223], v[222:223], v[114:115]
  v_exp_f32 v216, v216
  v_exp_f32 v217, v217
  v_exp_f32 v218, v218
  v_exp_f32 v219, v219
  v_exp_f32 v220, v220
  v_exp_f32 v221, v221
  v_exp_f32 v222, v222
  v_exp_f32 v223, v223
  v_pk_fma_f32 v[216:217], v[216:217], s[8:9], s[8:9]
  v_pk_fma_f32 v[218:219], v[218:219], s[8:9], s[8:9]
  v_pk_fma_f32 v[220:221], v[220:221], s[8:9], s[8:9]
  v_pk_fma_f32 v[222:223], v[222:223], s[8:9], s[8:9]
  v_rcp_f32 v216, v216
  v_rcp_f32 v217, v217
  v_rcp_f32 v218, v218
  v_rcp_f32 v219, v219
  v_rcp_f32 v220, v220
  v_rcp_f32 v221, v221
  v_rcp_f32 v222, v222
  v_rcp_f32 v223, v223
  v_permlane32_swap_b32 v100, v102
  v_permlane32_swap_b32 v101, v103
  buffer_store_dwordx4 v[100:103], v236, s[20:23], s10 offen sc1
  ds_write_b128 v241, v[100:103] offset:0
  v_pk_mul_f32 v[108:109], v[108:109], v[216:217]
  v_pk_mul_f32 v[110:111], v[110:111], v[218:219]
  v_pk_mul_f32 v[112:113], v[112:113], v[220:221]
  v_pk_mul_f32 v[114:115], v[114:115], v[222:223]
  v_cvt_pk_bf16_f32 v108, v108, v109
  v_cvt_pk_bf16_f32 v109, v110, v111
  v_cvt_pk_bf16_f32 v110, v112, v113
  v_cvt_pk_bf16_f32 v111, v114, v115
  s_nop 0
  v_permlane32_swap_b32 v108, v110
  v_permlane32_swap_b32 v109, v111
  buffer_store_dwordx4 v[108:111], v236, s[20:23], s11 offen sc1
  ds_write_b128 v241, v[108:111] offset:4096
  s_setprio 0
K5_cons:
  s_lshr_b32 s31, s3, 1
  s_and_b32 s32, s3, 1
  s_and_b32 s29, s90, 1
  s_lshl_b32 s30, s89, 2
  s_lshl_b32 s4, s31, 1
  s_add_u32 s30, s30, s4
  s_lshl_b32 s27, s90, 1
  s_add_u32 s27, s27, s32
  s_mov_b32 s12, s50
  s_mov_b32 s13, s51
  s_mov_b32 s14, 0x800
  s_mov_b32 s15, 0x20000
  s_mov_b32 s16, s52
  s_mov_b32 s17, s53
  s_mov_b32 s18, 0x400000
  s_mov_b32 s19, 0x20000
  v_lshrrev_b32 v140, 4, v2
  v_lshlrev_b32 v140, 9, v140
  v_and_b32 v141, 15, v2
  v_lshl_add_u32 v135, v141, 4, v140
  s_lshl_b32 s4, s30, 16
  s_lshl_b32 s5, s27, 11
  s_add_u32 s4, s4, s5
  s_add_u32 s4, s4, 16777216
  s_lshl_b32 s5, s27, 6
  s_add_u32 s6, s4, 65536
  buffer_load_dwordx4 v[148:151], v135, s[20:23], s4 offen offset:0
  buffer_load_dwordx4 v[152:155], v135, s[20:23], s4 offen offset:256
  buffer_load_dwordx4 v[156:159], v135, s[20:23], s6 offen offset:0
  buffer_load_dwordx4 v[160:163], v135, s[20:23], s6 offen offset:256
  v_bfe_u32 v141, v2, 4, 1
  v_lshlrev_b32 v141, 5, v141
  v_lshrrev_b32 v142, 5, v2
  v_lshl_add_u32 v141, v142, 3, v141
  buffer_load_dwordx2 v[164:165], v141, s[12:15], s5 offen offset:0
  buffer_load_dwordx2 v[166:167], v141, s[12:15], s5 offen offset:16
  s_lshl_b32 s96, s89, 13
  s_lshl_b32 s5, s90, 4
  s_add_u32 s96, s96, s5
  s_lshl_b32 s5, s3, 2
  s_add_u32 s96, s96, s5
  s_add_u32 s96, s96, 57016320
  s_setprio 1
  s_lshl_b32 s4, s31, 13
  v_add_u32 v132, s4, v135
  s_lshl_b32 s4, s29, 1
  s_add_u32 s4, s4, s32
  s_lshl_b32 s4, s4, 12
  s_add_u32 s4, s4, 16384
  v_add_u32 v133, s4, v135
  v_xor_b32 v134, 8192, v133
  v_mov_b32 v84, 0
  v_mov_b32 v85, 0
  v_mov_b32 v86, 0
  v_mov_b32 v87, 0
  v_mov_b32 v88, 0
  v_mov_b32 v89, 0
  v_mov_b32 v90, 0
  v_mov_b32 v91, 0
  v_mov_b32 v92, 0
  v_mov_b32 v93, 0
  v_mov_b32 v94, 0
  v_mov_b32 v95, 0
  v_mov_b32 v96, 0
  v_mov_b32 v97, 0
  v_mov_b32 v98, 0
  v_mov_b32 v99, 0
  v_mov_b32 v116, 0
  v_mov_b32 v117, 0
  v_mov_b32 v118, 0
  v_mov_b32 v119, 0
  v_mov_b32 v120, 0
  v_mov_b32 v121, 0
  v_mov_b32 v122, 0
  v_mov_b32 v123, 0
  v_mov_b32 v124, 0
  v_mov_b32 v125, 0
  v_mov_b32 v126, 0
  v_mov_b32 v127, 0
  v_mov_b32 v128, 0
  v_mov_b32 v129, 0
  v_mov_b32 v130, 0
  v_mov_b32 v131, 0
  v_mov_b32 v36, 0
  v_mov_b32 v37, 0
  v_mov_b32 v38, 0
  v_mov_b32 v39, 0
  v_mov_b32 v40, 0
  v_mov_b32 v41, 0
  v_mov_b32 v42, 0
  v_mov_b32 v43, 0
  v_mov_b32 v44, 0
  v_mov_b32 v45, 0
  v_mov_b32 v46, 0
  v_mov_b32 v47, 0
  v_mov_b32 v48, 0
  v_mov_b32 v49, 0
  v_mov_b32 v50, 0
  v_mov_b32 v51, 0
  v_mov_b32 v52, 0
  v_mov_b32 v53, 0
  v_mov_b32 v54, 0
  v_mov_b32 v55, 0
  v_mov_b32 v56, 0
  v_mov_b32 v57, 0
  v_mov_b32 v58, 0
  v_mov_b32 v59, 0
  v_mov_b32 v60, 0
  v_mov_b32 v61, 0
  v_mov_b32 v62, 0
  v_mov_b32 v63, 0
  v_mov_b32 v64, 0
  v_mov_b32 v65, 0
  v_mov_b32 v66, 0
  v_mov_b32 v67, 0
  s_mov_b32 s35, 22
  v_mov_b32 v4, 0
  v_mov_b32 v5, 0
  v_mov_b32 v6, 0
  v_mov_b32 v7, 0
  v_mov_b32 v8, 0
  v_mov_b32 v9, 0
  v_mov_b32 v10, 0
  v_mov_b32 v11, 0
  v_mov_b32 v12, 0
  v_mov_b32 v13, 0
  v_mov_b32 v14, 0
  v_mov_b32 v15, 0
  v_mov_b32 v16, 0
  v_mov_b32 v17, 0
  v_mov_b32 v18, 0
  v_mov_b32 v19, 0
  v_mov_b32 v20, 0
  v_mov_b32 v21, 0
  v_mov_b32 v22, 0
  v_mov_b32 v23, 0
  v_mov_b32 v24, 0
  v_mov_b32 v25, 0
  v_mov_b32 v26, 0
  v_mov_b32 v27, 0
  v_mov_b32 v28, 0
  v_mov_b32 v29, 0
  v_mov_b32 v30, 0
  v_mov_b32 v31, 0
  v_mov_b32 v32, 0
  v_mov_b32 v33, 0
  v_mov_b32 v34, 0
  v_mov_b32 v35, 0
  s_mov_b32 s34, 0
  s_mov_b32 s58, 0xfffe8000
  s_mov_b32 s59, 32768
K5_cloop:
  s_waitcnt lgkmcnt(0)
  s_barrier
  v_mfma_f32_16x16x32_bf16 v[4:7], v[116:119], v[84:87], v[4:7]
  ds_read_b128 v[68:71], v132 offset:0
  v_mfma_f32_16x16x32_bf16 v[12:15], v[116:119], v[88:91], v[12:15]
  ds_read_b128 v[100:103], v133 offset:0
  v_mfma_f32_16x16x32_bf16 v[20:23], v[116:119], v[92:95], v[20:23]
  ds_read_b128 v[72:75], v132 offset:256
  v_mfma_f32_16x16x32_bf16 v[28:31], v[116:119], v[96:99], v[28:31]
  ds_read_b128 v[76:79], v132 offset:4096
  v_mfma_f32_16x16x32_bf16 v[32:35], v[120:123], v[96:99], v[32:35]
  ds_read_b128 v[80:83], v132 offset:4352
  v_mfma_f32_16x16x32_bf16 v[24:27], v[120:123], v[92:95], v[24:27]
  ds_read_b128 v[104:107], v133 offset:256
  v_mfma_f32_16x16x32_bf16 v[16:19], v[120:123], v[88:91], v[16:19]
  ds_read_b128 v[108:111], v134 offset:0
  v_mfma_f32_16x16x32_bf16 v[8:11], v[120:123], v[84:87], v[8:11]
  ds_read_b128 v[112:115], v134 offset:256
  v_mfma_f32_16x16x32_bf16 v[36:39], v[124:127], v[84:87], v[36:39]
  s_add_u32 s34, s34, 1
  v_mfma_f32_16x16x32_bf16 v[44:47], v[124:127], v[88:91], v[44:47]
  s_cmp_eq_u32 s34, 4
  v_mfma_f32_16x16x32_bf16 v[52:55], v[124:127], v[92:95], v[52:55]
  s_cselect_b32 s33, s58, s59
  v_mfma_f32_16x16x32_bf16 v[60:63], v[124:127], v[96:99], v[60:63]
  s_cselect_b32 s34, 0, s34
  v_mfma_f32_16x16x32_bf16 v[64:67], v[128:131], v[96:99], v[64:67]
  s_cmp_eq_u32 s35, 22
  v_mfma_f32_16x16x32_bf16 v[56:59], v[128:131], v[92:95], v[56:59]
  v_mfma_f32_16x16x32_bf16 v[48:51], v[128:131], v[88:91], v[48:51]
  v_mfma_f32_16x16x32_bf16 v[40:43], v[128:131], v[84:87], v[40:43]
  s_cbranch_scc1 K5_ev0
K5_back0:
  s_waitcnt lgkmcnt(0)
  v_mfma_f32_16x16x32_bf16 v[4:7], v[100:103], v[68:71], v[4:7]
  ds_read_b128 v[84:87], v132 offset:2048
  v_mfma_f32_16x16x32_bf16 v[12:15], v[100:103], v[72:75], v[12:15]
  ds_read_b128 v[116:119], v133 offset:2048
  v_mfma_f32_16x16x32_bf16 v[20:23], v[100:103], v[76:79], v[20:23]
  ds_read_b128 v[88:91], v132 offset:2304
  v_mfma_f32_16x16x32_bf16 v[28:31], v[100:103], v[80:83], v[28:31]
  ds_read_b128 v[92:95], v132 offset:6144
  v_mfma_f32_16x16x32_bf16 v[32:35], v[104:107], v[80:83], v[32:35]
  ds_read_b128 v[96:99], v132 offset:6400
  v_mfma_f32_16x16x32_bf16 v[24:27], v[104:107], v[76:79], v[24:27]
  ds_read_b128 v[120:123], v133 offset:2304
  v_mfma_f32_16x16x32_bf16 v[16:19], v[104:107], v[72:75], v[16:19]
  ds_read_b128 v[124:127], v134 offset:2048
  v_mfma_f32_16x16x32_bf16 v[8:11], v[104:107], v[68:71], v[8:11]
  ds_read_b128 v[128:131], v134 offset:2304
  v_mfma_f32_16x16x32_bf16 v[36:39], v[108:111], v[68:71], v[36:39]
  v_add_u32 v132, s33, v132
  v_mfma_f32_16x16x32_bf16 v[44:47], v[108:111], v[72:75], v[44:47]
  v_add_u32 v133, s33, v133
  v_mfma_f32_16x16x32_bf16 v[52:55], v[108:111], v[76:79], v[52:55]
  v_add_u32 v134, s33, v134
  v_mfma_f32_16x16x32_bf16 v[60:63], v[108:111], v[80:83], v[60:63]
  s_sub_u32 s35, s35, 1
  v_mfma_f32_16x16x32_bf16 v[64:67], v[112:115], v[80:83], v[64:67]
  s_cmp_lg_u32 s35, 0
  v_mfma_f32_16x16x32_bf16 v[56:59], v[112:115], v[76:79], v[56:59]
  v_mfma_f32_16x16x32_bf16 v[48:51], v[112:115], v[72:75], v[48:51]
  v_mfma_f32_16x16x32_bf16 v[40:43], v[112:115], v[68:71], v[40:43]
  s_cbranch_scc1 K5_cloop
  s_lshl_b32 s4, s29, 13
  v_subrev_u32 v133, s4, v133
  s_lshl_b32 s8, s89, 4
  s_add_u32 s8, s8, s90
  s_lshl_b32 s4, s8, 15
  s_lshl_b32 s5, s3, 13
  s_add_u32 s4, s4, s5
  s_add_u32 s4, s4, 67108864
  s_lshl_b32 s96, s8, 7
  s_lshl_b32 s5, s3, 2
  s_add_u32 s96, s96, s5
  s_add_u32 s96, s96, 56098816
  s_mov_b32 s35, 12
  s_add_u32 s5, s4, 4096
  s_waitcnt lgkmcnt(0)
  s_barrier
  v_mfma_f32_16x16x32_bf16 v[36:39], v[124:127], v[84:87], v[36:39]
  ds_read_b128 v[68:71], v132 offset:0
  v_mfma_f32_16x16x32_bf16 v[44:47], v[124:127], v[88:91], v[44:47]
  ds_read_b128 v[100:103], v133 offset:0
  v_mfma_f32_16x16x32_bf16 v[52:55], v[124:127], v[92:95], v[52:55]
  ds_read_b128 v[72:75], v132 offset:256
  v_mfma_f32_16x16x32_bf16 v[60:63], v[124:127], v[96:99], v[60:63]
  ds_read_b128 v[76:79], v132 offset:4096
  v_mfma_f32_16x16x32_bf16 v[64:67], v[128:131], v[96:99], v[64:67]
  ds_read_b128 v[80:83], v132 offset:4352
  v_mfma_f32_16x16x32_bf16 v[56:59], v[128:131], v[92:95], v[56:59]
  ds_read_b128 v[104:107], v133 offset:256
  v_mfma_f32_16x16x32_bf16 v[48:51], v[128:131], v[88:91], v[48:51]
  s_add_u32 s34, s34, 1
  v_mfma_f32_16x16x32_bf16 v[40:43], v[128:131], v[84:87], v[40:43]
  s_cmp_eq_u32 s34, 4
  v_mfma_f32_16x16x32_bf16 v[4:7], v[116:119], v[84:87], v[4:7]
  s_cselect_b32 s33, s58, s59
  v_mfma_f32_16x16x32_bf16 v[12:15], v[116:119], v[88:91], v[12:15]
  s_cselect_b32 s34, 0, s34
  v_mfma_f32_16x16x32_bf16 v[20:23], v[116:119], v[92:95], v[20:23]
  v_mfma_f32_16x16x32_bf16 v[28:31], v[116:119], v[96:99], v[28:31]
  v_mfma_f32_16x16x32_bf16 v[32:35], v[120:123], v[96:99], v[32:35]
  v_mfma_f32_16x16x32_bf16 v[24:27], v[120:123], v[92:95], v[24:27]
  v_mfma_f32_16x16x32_bf16 v[16:19], v[120:123], v[88:91], v[16:19]
  v_mfma_f32_16x16x32_bf16 v[8:11], v[120:123], v[84:87], v[8:11]
  s_waitcnt lgkmcnt(0)
  v_mfma_f32_16x16x32_bf16 v[4:7], v[100:103], v[68:71], v[4:7]
  ds_read_b128 v[84:87], v132 offset:2048
  ds_read_b128 v[116:119], v133 offset:2048
  ds_read_b128 v[88:91], v132 offset:2304
  v_mfma_f32_16x16x32_bf16 v[12:15], v[100:103], v[72:75], v[12:15]
  ds_read_b128 v[92:95], v132 offset:6144
  ds_read_b128 v[96:99], v132 offset:6400
  v_mfma_f32_16x16x32_bf16 v[20:23], v[100:103], v[76:79], v[20:23]
  ds_read_b128 v[120:123], v133 offset:2304
  v_add_u32 v132, s33, v132
  v_mfma_f32_16x16x32_bf16 v[28:31], v[100:103], v[80:83], v[28:31]
  v_add_u32 v133, s33, v133
  s_sub_u32 s35, s35, 1
  v_mfma_f32_16x16x32_bf16 v[32:35], v[104:107], v[80:83], v[32:35]
  s_cmp_lg_u32 s35, 0
  buffer_store_dwordx4 v[36:39], v3, s[20:23], s4 offen offset:0 sc1
  buffer_store_dwordx4 v[40:43], v3, s[20:23], s4 offen offset:1024 sc1
  v_mfma_f32_16x16x32_bf16 v[24:27], v[104:107], v[76:79], v[24:27]
  buffer_store_dwordx4 v[44:47], v3, s[20:23], s4 offen offset:2048 sc1
  buffer_store_dwordx4 v[48:51], v3, s[20:23], s4 offen offset:3072 sc1
  v_mfma_f32_16x16x32_bf16 v[16:19], v[104:107], v[72:75], v[16:19]
  buffer_store_dwordx4 v[52:55], v3, s[20:23], s5 offen offset:0 sc1
  buffer_store_dwordx4 v[56:59], v3, s[20:23], s5 offen offset:1024 sc1
  v_mfma_f32_16x16x32_bf16 v[8:11], v[104:107], v[68:71], v[8:11]
  buffer_store_dwordx4 v[60:63], v3, s[20:23], s5 offen offset:2048 sc1
  buffer_store_dwordx4 v[64:67], v3, s[20:23], s5 offen offset:3072 sc1
K5_hloop:
  s_waitcnt lgkmcnt(0)
  s_barrier
  v_mfma_f32_16x16x32_bf16 v[4:7], v[116:119], v[84:87], v[4:7]
  ds_read_b128 v[68:71], v132 offset:0
  ds_read_b128 v[100:103], v133 offset:0
  v_mfma_f32_16x16x32_bf16 v[12:15], v[116:119], v[88:91], v[12:15]
  ds_read_b128 v[72:75], v132 offset:256
  ds_read_b128 v[76:79], v132 offset:4096
  v_mfma_f32_16x16x32_bf16 v[20:23], v[116:119], v[92:95], v[20:23]
  ds_read_b128 v[80:83], v132 offset:4352
  ds_read_b128 v[104:107], v133 offset:256
  v_mfma_f32_16x16x32_bf16 v[28:31], v[116:119], v[96:99], v[28:31]
  s_add_u32 s34, s34, 1
  s_cmp_eq_u32 s34, 4
  v_mfma_f32_16x16x32_bf16 v[32:35], v[120:123], v[96:99], v[32:35]
  s_cselect_b32 s33, s58, s59
  s_cselect_b32 s34, 0, s34
  v_mfma_f32_16x16x32_bf16 v[24:27], v[120:123], v[92:95], v[24:27]
  s_cmp_eq_u32 s35, 9
  v_mfma_f32_16x16x32_bf16 v[16:19], v[120:123], v[88:91], v[16:19]
  v_mfma_f32_16x16x32_bf16 v[8:11], v[120:123], v[84:87], v[8:11]
  s_cbranch_scc1 K5_ev
K5_back:
  s_waitcnt lgkmcnt(0)
  v_mfma_f32_16x16x32_bf16 v[4:7], v[100:103], v[68:71], v[4:7]
  ds_read_b128 v[84:87], v132 offset:2048
  ds_read_b128 v[116:119], v133 offset:2048
  v_mfma_f32_16x16x32_bf16 v[12:15], v[100:103], v[72:75], v[12:15]
  ds_read_b128 v[88:91], v132 offset:2304
  ds_read_b128 v[92:95], v132 offset:6144
  v_mfma_f32_16x16x32_bf16 v[20:23], v[100:103], v[76:79], v[20:23]
  ds_read_b128 v[96:99], v132 offset:6400
  ds_read_b128 v[120:123], v133 offset:2304
  v_mfma_f32_16x16x32_bf16 v[28:31], v[100:103], v[80:83], v[28:31]
  v_add_u32 v132, s33, v132
  v_add_u32 v133, s33, v133
  v_mfma_f32_16x16x32_bf16 v[32:35], v[104:107], v[80:83], v[32:35]
  s_sub_u32 s35, s35, 1
  s_cmp_lg_u32 s35, 0
  v_mfma_f32_16x16x32_bf16 v[24:27], v[104:107], v[76:79], v[24:27]
  v_mfma_f32_16x16x32_bf16 v[16:19], v[104:107], v[72:75], v[16:19]
  v_mfma_f32_16x16x32_bf16 v[8:11], v[104:107], v[68:71], v[8:11]
  s_cbranch_scc1 K5_hloop
  s_waitcnt lgkmcnt(0)
  v_mfma_f32_16x16x32_bf16 v[4:7], v[116:119], v[84:87], v[4:7]
  s_lshl_b32 s4, s3, 13
  s_add_u32 s4, s4, 65536
  v_add_u32 v140, s4, v3
  s_lshl_b32 s6, s31, 13
  v_mfma_f32_16x16x32_bf16 v[12:15], v[116:119], v[88:91], v[12:15]
  s_add_u32 s6, s6, 98304
  v_bfe_u32 v142, v2, 4, 1
  v_lshlrev_b32 v142, 1, v142
  v_lshrrev_b32 v141, 5, v2
  v_mfma_f32_16x16x32_bf16 v[20:23], v[116:119], v[92:95], v[20:23]
  v_add_u32 v142, v142, v141
  s_lshl_b32 s5, s32, 2
  v_add_u32 v142, s5, v142
  v_and_b32 v143, 7, v2
  v_mfma_f32_16x16x32_bf16 v[28:31], v[116:119], v[96:99], v[28:31]
  v_xor_b32 v142, v142, v143
  v_lshlrev_b32 v142, 4, v142
  v_and_b32 v141, 15, v2
  v_lshl_add_u32 v141, v141, 7, v142
  v_mfma_f32_16x16x32_bf16 v[32:35], v[120:123], v[96:99], v[32:35]
  v_add_u32 v141, s6, v141
  v_lshrrev_b32 v145, 3, v2
  v_xor_b32 v144, v143, v145
  v_lshlrev_b32 v144, 4, v144
  v_mfma_f32_16x16x32_bf16 v[24:27], v[120:123], v[92:95], v[24:27]
  v_lshl_add_u32 v144, v145, 7, v144
  s_lshl_b32 s5, s3, 12
  s_add_u32 s5, s5, 98304
  v_add_u32 v144, s5, v144
  v_mfma_f32_16x16x32_bf16 v[16:19], v[120:123], v[88:91], v[16:19]
  v_lshlrev_b32 v143, 4, v143
  v_lshl_add_u32 v145, v145, 11, v143
  s_lshl_b32 s4, s89, 2
  s_add_u32 s4, s4, s3
  v_mfma_f32_16x16x32_bf16 v[8:11], v[120:123], v[84:87], v[8:11]
  s_lshl_b32 s4, s4, 16
  s_lshl_b32 s5, s90, 7
  s_add_u32 s4, s4, s5
  s_barrier
  ds_read_b128 v[176:179], v140 offset:0
  ds_read_b128 v[180:183], v140 offset:1024
  ds_read_b128 v[184:187], v140 offset:2048
  ds_read_b128 v[188:191], v140 offset:3072
  ds_read_b128 v[192:195], v140 offset:4096
  ds_read_b128 v[196:199], v140 offset:5120
  ds_read_b128 v[200:203], v140 offset:6144
  ds_read_b128 v[204:207], v140 offset:7168
  s_waitcnt lgkmcnt(6)
  v_pk_add_f32 v[4:5], v[4:5], v[176:177]
  v_pk_add_f32 v[6:7], v[6:7], v[178:179]
  v_pk_add_f32 v[8:9], v[8:9], v[180:181]
  v_pk_add_f32 v[10:11], v[10:11], v[182:183]
  v_pk_add_f32 v[4:5], v[4:5], v[36:37]
  v_pk_add_f32 v[6:7], v[6:7], v[38:39]
  v_pk_add_f32 v[8:9], v[8:9], v[40:41]
  v_pk_add_f32 v[10:11], v[10:11], v[42:43]
  v_cvt_pk_bf16_f32 v4, v4, v5
  v_cvt_pk_bf16_f32 v5, v6, v7
  v_cvt_pk_bf16_f32 v6, v8, v9
  v_cvt_pk_bf16_f32 v7, v10, v11
  s_waitcnt lgkmcnt(4)
  v_pk_add_f32 v[12:13], v[12:13], v[184:185]
  v_pk_add_f32 v[14:15], v[14:15], v[186:187]
  v_pk_add_f32 v[16:17], v[16:17], v[188:189]
  v_pk_add_f32 v[18:19], v[18:19], v[190:191]
  v_pk_add_f32 v[12:13], v[12:13], v[44:45]
  v_pk_add_f32 v[14:15], v[14:15], v[46:47]
  v_pk_add_f32 v[16:17], v[16:17], v[48:49]
  v_pk_add_f32 v[18:19], v[18:19], v[50:51]
  v_permlane32_swap_b32 v4, v6
  v_permlane32_swap_b32 v5, v7
  ds_write_b128 v141, v[4:7] offset:0
  v_cvt_pk_bf16_f32 v12, v12, v13
  v_cvt_pk_bf16_f32 v13, v14, v15
  v_cvt_pk_bf16_f32 v14, v16, v17
  v_cvt_pk_bf16_f32 v15, v18, v19
  s_waitcnt lgkmcnt(3)
  v_pk_add_f32 v[20:21], v[20:21], v[192:193]
  v_pk_add_f32 v[22:23], v[22:23], v[194:195]
  v_pk_add_f32 v[24:25], v[24:25], v[196:197]
  v_pk_add_f32 v[26:27], v[26:27], v[198:199]
  v_pk_add_f32 v[20:21], v[20:21], v[52:53]
  v_pk_add_f32 v[22:23], v[22:23], v[54:55]
  v_pk_add_f32 v[24:25], v[24:25], v[56:57]
  v_pk_add_f32 v[26:27], v[26:27], v[58:59]
  v_permlane32_swap_b32 v12, v14
  v_permlane32_swap_b32 v13, v15
  ds_write_b128 v141, v[12:15] offset:2048
  v_cvt_pk_bf16_f32 v20, v20, v21
  v_cvt_pk_bf16_f32 v21, v22, v23
  v_cvt_pk_bf16_f32 v22, v24, v25
  v_cvt_pk_bf16_f32 v23, v26, v27
  s_waitcnt lgkmcnt(2)
  v_pk_add_f32 v[28:29], v[28:29], v[200:201]
  v_pk_add_f32 v[30:31], v[30:31], v[202:203]
  v_pk_add_f32 v[32:33], v[32:33], v[204:205]
  v_pk_add_f32 v[34:35], v[34:35], v[206:207]
  v_pk_add_f32 v[28:29], v[28:29], v[60:61]
  v_pk_add_f32 v[30:31], v[30:31], v[62:63]
  v_pk_add_f32 v[32:33], v[32:33], v[64:65]
  v_pk_add_f32 v[34:35], v[34:35], v[66:67]
  v_permlane32_swap_b32 v20, v22
  v_permlane32_swap_b32 v21, v23
  ds_write_b128 v141, v[20:23] offset:4096
  v_cvt_pk_bf16_f32 v28, v28, v29
  v_cvt_pk_bf16_f32 v29, v30, v31
  v_cvt_pk_bf16_f32 v30, v32, v33
  v_cvt_pk_bf16_f32 v31, v34, v35
  s_nop 0
  v_permlane32_swap_b32 v28, v30
  v_permlane32_swap_b32 v29, v31
  ds_write_b128 v141, v[28:31] offset:6144
  s_waitcnt lgkmcnt(0)
  s_barrier
  ds_read_b128 v[176:179], v144 offset:0
  ds_read_b128 v[180:183], v144 offset:1024
  ds_read_b128 v[184:187], v144 offset:2048
  ds_read_b128 v[188:191], v144 offset:3072
  s_waitcnt lgkmcnt(3)
  buffer_store_dwordx4 v[176:179], v145, s[16:19], s4 offen sc1
  s_add_u32 s4, s4, 16384
  s_waitcnt lgkmcnt(2)
  buffer_store_dwordx4 v[180:183], v145, s[16:19], s4 offen sc1
  s_add_u32 s4, s4, 16384
  s_waitcnt lgkmcnt(1)
  buffer_store_dwordx4 v[184:187], v145, s[16:19], s4 offen sc1
  s_add_u32 s4, s4, 16384
  s_waitcnt lgkmcnt(0)
  buffer_store_dwordx4 v[188:191], v145, s[16:19], s4 offen sc1
  s_add_u32 s4, s4, 16384
  s_endpgm
K5_ev0:
  s_waitcnt vmcnt(6)
  v_mov_b32 v140, s88
  v_lshlrev_b32 v141, 9, v2
  s_mov_b64 exec, 0xffff
  buffer_store_dword v140, v141, s[20:23], s96 offen sc1
  s_mov_b64 exec, -1
  s_branch K5_back0
K5_ev:
  s_waitcnt vmcnt(0)
  v_mov_b32 v140, s88
  s_mov_b64 exec, 1
  buffer_store_dword v140, off, s[20:23], s96 sc1
  s_mov_b64 exec, -1
  v_permlane32_swap_b32 v148, v150
  v_permlane32_swap_b32 v149, v151
  v_permlane32_swap_b32 v152, v154
  v_permlane32_swap_b32 v153, v155
  v_permlane32_swap_b32 v156, v158
  v_permlane32_swap_b32 v157, v159
  v_permlane32_swap_b32 v160, v162
  v_permlane32_swap_b32 v161, v163
  v_lshlrev_b32 v168, 16, v164
  v_and_b32 v169, 0xffff0000, v164
  v_lshlrev_b32 v170, 16, v165
  v_and_b32 v171, 0xffff0000, v165
  v_lshlrev_b32 v172, 16, v166
  v_and_b32 v173, 0xffff0000, v166
  v_lshlrev_b32 v174, 16, v167
  v_and_b32 v175, 0xffff0000, v167
  v_lshlrev_b32 v36, 16, v148
  v_and_b32 v37, 0xffff0000, v148
  v_lshlrev_b32 v38, 16, v149
  v_and_b32 v39, 0xffff0000, v149
  v_lshlrev_b32 v40, 16, v150
  v_and_b32 v41, 0xffff0000, v150
  v_lshlrev_b32 v42, 16, v151
  v_and_b32 v43, 0xffff0000, v151
  v_pk_add_f32 v[36:37], v[36:37], v[168:169]
  v_pk_add_f32 v[38:39], v[38:39], v[170:171]
  v_pk_add_f32 v[40:41], v[40:41], v[172:173]
  v_pk_add_f32 v[42:43], v[42:43], v[174:175]
  v_lshlrev_b32 v44, 16, v152
  v_and_b32 v45, 0xffff0000, v152
  v_lshlrev_b32 v46, 16, v153
  v_and_b32 v47, 0xffff0000, v153
  v_lshlrev_b32 v48, 16, v154
  v_and_b32 v49, 0xffff0000, v154
  v_lshlrev_b32 v50, 16, v155
  v_and_b32 v51, 0xffff0000, v155
  v_pk_add_f32 v[44:45], v[44:45], v[168:169]
  v_pk_add_f32 v[46:47], v[46:47], v[170:171]
  v_pk_add_f32 v[48:49], v[48:49], v[172:173]
  v_pk_add_f32 v[50:51], v[50:51], v[174:175]
  v_lshlrev_b32 v52, 16, v156
  v_and_b32 v53, 0xffff0000, v156
  v_lshlrev_b32 v54, 16, v157
  v_and_b32 v55, 0xffff0000, v157
  v_lshlrev_b32 v56, 16, v158
  v_and_b32 v57, 0xffff0000, v158
  v_lshlrev_b32 v58, 16, v159
  v_and_b32 v59, 0xffff0000, v159
  v_pk_add_f32 v[52:53], v[52:53], v[168:169]
  v_pk_add_f32 v[54:55], v[54:55], v[170:171]
  v_pk_add_f32 v[56:57], v[56:57], v[172:173]
  v_pk_add_f32 v[58:59], v[58:59], v[174:175]
  v_lshlrev_b32 v60, 16, v160
  v_and_b32 v61, 0xffff0000, v160
  v_lshlrev_b32 v62, 16, v161
  v_and_b32 v63, 0xffff0000, v161
  v_lshlrev_b32 v64, 16, v162
  v_and_b32 v65, 0xffff0000, v162
  v_lshlrev_b32 v66, 16, v163
  v_and_b32 v67, 0xffff0000, v163
  v_pk_add_f32 v[60:61], v[60:61], v[168:169]
  v_pk_add_f32 v[62:63], v[62:63], v[170:171]
  v_pk_add_f32 v[64:65], v[64:65], v[172:173]
  v_pk_add_f32 v[66:67], v[66:67], v[174:175]
  s_branch K5_back
K3_load:
  s_sub_u32 s30, s3, 4
  s_lshl_b32 s34, s30, 10
  s_mul_i32 s31, s89, 262144
  s_add_u32 s31, s31, s34
  s_add_u32 s31, s31, 12582912
  s_mul_i32 s32, s90, 131072
  s_add_u32 s32, s32, s34
  s_add_u32 s32, s32, 35651584
  s_add_u32 m0, s34, 16384
  s_add_u32 s35, s32, 0
  buffer_load_dwordx4 v3, s[20:23], s35 offen lds
  s_add_u32 m0, s34, 20480
  s_add_u32 s35, s32, 65536
  buffer_load_dwordx4 v3, s[20:23], s35 offen lds
  s_add_u32 m0, s34, 40960
  s_add_u32 s35, s32, 4096
  buffer_load_dwordx4 v3, s[20:23], s35 offen lds
  s_add_u32 m0, s34, 45056
  s_add_u32 s35, s32, 69632
  buffer_load_dwordx4 v3, s[20:23], s35 offen lds
  s_add_u32 m0, s34, 65536
  s_add_u32 s35, s32, 8192
  buffer_load_dwordx4 v3, s[20:23], s35 offen lds
  s_add_u32 m0, s34, 69632
  s_add_u32 s35, s32, 73728
  buffer_load_dwordx4 v3, s[20:23], s35 offen lds
  s_add_u32 m0, s34, 90112
  s_add_u32 s35, s32, 12288
  buffer_load_dwordx4 v3, s[20:23], s35 offen lds
  s_add_u32 m0, s34, 94208
  s_add_u32 s35, s32, 77824
  buffer_load_dwordx4 v3, s[20:23], s35 offen lds
  s_add_u32 m0, s34, 114688
  s_add_u32 s35, s32, 16384
  buffer_load_dwordx4 v3, s[20:23], s35 offen lds
  s_add_u32 m0, s34, 118784
  s_add_u32 s35, s32, 81920
  buffer_load_dwordx4 v3, s[20:23], s35 offen lds
  s_add_u32 m0, s34, 139264
  s_add_u32 s35, s32, 20480
  buffer_load_dwordx4 v3, s[20:23], s35 offen lds
  s_add_u32 m0, s34, 143360
  s_add_u32 s35, s32, 86016
  buffer_load_dwordx4 v3, s[20:23], s35 offen lds
  s_getpc_b64 s[6:7]
CREF_10:
  s_sub_u32 s6, s6, CREF_10-K3_cons
  s_subb_u32 s7, s7, 0
  s_lshl_b32 s5, s30, 12
  v_lshlrev_b32 v42, 6, v2
  v_add_u32 v42, s5, v42
  v_min_u32 v42, CODE_END-K3_cons-4, v42
  global_load_dword v43, v42, s[6:7]
  s_waitcnt vmcnt(0)
  s_barrier
  s_add_u32 m0, s34, 0
  s_add_u32 s35, s31, 0
  buffer_load_dwordx4 v3, s[20:23], s35 offen lds
  s_add_u32 m0, s34, 4096
  s_add_u32 s35, s31, 65536
  buffer_load_dwordx4 v3, s[20:23], s35 offen lds
  s_add_u32 m0, s34, 8192
  s_add_u32 s35, s31, 131072
  buffer_load_dwordx4 v3, s[20:23], s35 offen lds
  s_add_u32 m0, s34, 12288
  s_add_u32 s35, s31, 196608
  buffer_load_dwordx4 v3, s[20:23], s35 offen lds
  s_add_u32 m0, s34, 24576
  s_add_u32 s35, s31, 4096
  buffer_load_dwordx4 v3, s[20:23], s35 offen lds
  s_add_u32 m0, s34, 28672
  s_add_u32 s35, s31, 69632
  buffer_load_dwordx4 v3, s[20:23], s35 offen lds
  s_add_u32 m0, s34, 32768
  s_add_u32 s35, s31, 135168
  buffer_load_dwordx4 v3, s[20:23], s35 offen lds
  s_add_u32 m0, s34, 36864
  s_add_u32 s35, s31, 200704
  buffer_load_dwordx4 v3, s[20:23], s35 offen lds
  s_add_u32 m0, s34, 49152
  s_add_u32 s35, s31, 8192
  buffer_load_dwordx4 v3, s[20:23], s35 offen lds
  s_add_u32 m0, s34, 53248
  s_add_u32 s35, s31, 73728
  buffer_load_dwordx4 v3, s[20:23], s35 offen lds
  s_add_u32 m0, s34, 57344
  s_add_u32 s35, s31, 139264
  buffer_load_dwordx4 v3, s[20:23], s35 offen lds
  s_add_u32 m0, s34, 61440
  s_add_u32 s35, s31, 204800
  buffer_load_dwordx4 v3, s[20:23], s35 offen lds
  s_add_u32 m0, s34, 73728
  s_add_u32 s35, s31, 12288
  buffer_load_dwordx4 v3, s[20:23], s35 offen lds
  s_add_u32 m0, s34, 77824
  s_add_u32 s35, s31, 77824
  buffer_load_dwordx4 v3, s[20:23], s35 offen lds
  s_add_u32 m0, s34, 81920
  s_add_u32 s35, s31, 143360
  buffer_load_dwordx4 v3, s[20:23], s35 offen lds
  s_add_u32 m0, s34, 86016
  s_add_u32 s35, s31, 208896
  buffer_load_dwordx4 v3, s[20:23], s35 offen lds
  s_add_u32 m0, s34, 98304
  s_add_u32 s35, s31, 16384
  buffer_load_dwordx4 v3, s[20:23], s35 offen lds
  s_add_u32 m0, s34, 102400
  s_add_u32 s35, s31, 81920
  buffer_load_dwordx4 v3, s[20:23], s35 offen lds
  s_add_u32 m0, s34, 106496
  s_add_u32 s35, s31, 147456
  buffer_load_dwordx4 v3, s[20:23], s35 offen lds
  s_add_u32 m0, s34, 110592
  s_add_u32 s35, s31, 212992
  buffer_load_dwordx4 v3, s[20:23], s35 offen lds
  s_add_u32 m0, s34, 122880
  s_add_u32 s35, s31, 20480
  buffer_load_dwordx4 v3, s[20:23], s35 offen lds
  s_add_u32 m0, s34, 126976
  s_add_u32 s35, s31, 86016
  buffer_load_dwordx4 v3, s[20:23], s35 offen lds
  s_add_u32 m0, s34, 131072
  s_add_u32 s35, s31, 151552
  buffer_load_dwordx4 v3, s[20:23], s35 offen lds
  s_add_u32 m0, s34, 135168
  s_add_u32 s35, s31, 217088
  buffer_load_dwordx4 v3, s[20:23], s35 offen lds
  s_add_u32 s31, s31, 24576
  s_add_u32 s32, s32, 24576
  s_mov_b32 s33, s34
  s_waitcnt vmcnt(20)
  s_barrier
  s_waitcnt vmcnt(16)
  s_barrier
  s_call_b64 s[92:93], K3_issue
  s_waitcnt vmcnt(18)
  s_barrier
  s_call_b64 s[92:93], K3_issue
  s_waitcnt vmcnt(20)
  s_barrier
  s_call_b64 s[92:93], K3_issue
  s_waitcnt vmcnt(22)
  s_barrier
  s_call_b64 s[92:93], K3_issue
  s_waitcnt vmcnt(24)
  s_barrier
  s_call_b64 s[92:93], K3_issue
  s_mov_b32 s29, 5
K3_lloop:
  s_waitcnt vmcnt(24)
  s_barrier
  s_call_b64 s[92:93], K3_issue
  s_sub_u32 s29, s29, 1
  s_cmp_lg_u32 s29, 0
  s_cbranch_scc1 K3_lloop
  s_lshr_b32 s8, s34, 1
  s_add_u32 s8, s8, 55969792
  v_lshlrev_b32 v46, 3, v2
  buffer_load_dwordx2 v[44:45], v46, s[20:23], s8 offen sc1
  s_waitcnt vmcnt(25)
  s_barrier
  s_waitcnt vmcnt(19)
  s_barrier
  s_waitcnt vmcnt(13)
  s_barrier
  s_waitcnt vmcnt(7)
  s_barrier
  s_waitcnt vmcnt(0)
  s_barrier
  s_mov_b32 s91, 200000
  v_cmp_ne_u32 vcc, s88, v44
  v_cmp_ne_u32 s[62:63], s88, v45
  s_nop 0
  s_or_b64 vcc, vcc, s[62:63]
  s_cbranch_vccz POK_11
PTOP_12:
  buffer_load_dwordx2 v[44:45], v46, s[20:23], s8 offen sc1
  s_waitcnt vmcnt(0)
  v_cmp_ne_u32 vcc, s88, v44
  v_cmp_ne_u32 s[62:63], s88, v45
  s_nop 0
  s_or_b64 vcc, vcc, s[62:63]
  s_cbranch_vccz POK_11
  s_sleep 4
  s_sub_u32 s91, s91, 1
  s_cmp_lg_u32 s91, 0
  s_cbranch_scc1 PTOP_12
POK_11:
  s_barrier
  s_branch K4_load
K3_issue:
  s_add_u32 m0, s33, 0
  s_add_u32 s35, s31, 0
  buffer_load_dwordx4 v3, s[20:23], s35 offen lds
  s_add_u32 m0, s33, 4096
  s_add_u32 s35, s31, 65536
  buffer_load_dwordx4 v3, s[20:23], s35 offen lds
  s_add_u32 m0, s33, 8192
  s_add_u32 s35, s31, 131072
  buffer_load_dwordx4 v3, s[20:23], s35 offen lds
  s_add_u32 m0, s33, 12288
  s_add_u32 s35, s31, 196608
  buffer_load_dwordx4 v3, s[20:23], s35 offen lds
  s_add_u32 m0, s33, 16384
  s_add_u32 s35, s32, 0
  buffer_load_dwordx4 v3, s[20:23], s35 offen lds
  s_add_u32 m0, s33, 20480
  s_add_u32 s35, s32, 65536
  buffer_load_dwordx4 v3, s[20:23], s35 offen lds
  s_add_u32 s31, s31, 4096
  s_add_u32 s32, s32, 4096
  s_add_u32 s33, s33, 24576
  s_cmp_ge_u32 s33, 147456
  s_cselect_b32 s33, s34, s33
  s_setpc_b64 s[92:93]
K4_load:
  s_sub_u32 s30, s3, 4
  s_lshl_b32 s34, s30, 10
  s_mul_i32 s31, s89, 262144
  s_add_u32 s31, s31, s34
  s_add_u32 s31, s31, 16777216
  s_mul_i32 s32, s90, 458752
  s_add_u32 s32, s32, s34
  s_add_u32 s32, s32, 37748736
  s_lshl_b32 s27, s90, 12
  s_mov_b32 s26, 0
  s_add_u32 m0, s34, 16384
  s_add_u32 s35, s32, 0
  s_add_u32 s35, s35, s27
  buffer_load_dwordx4 v3, s[20:23], s35 offen lds
  s_add_u32 m0, s34, 20480
  s_add_u32 s35, s32, 65536
  s_add_u32 s35, s35, s27
  buffer_load_dwordx4 v3, s[20:23], s35 offen lds
  s_add_u32 m0, s34, 24576
  s_add_u32 s35, s32, 131072
  s_add_u32 s35, s35, s27
  buffer_load_dwordx4 v3, s[20:23], s35 offen lds
  s_add_u32 m0, s34, 28672
  s_add_u32 s35, s32, 196608
  s_add_u32 s35, s35, s27
  buffer_load_dwordx4 v3, s[20:23], s35 offen lds
  s_add_u32 m0, s34, 32768
  s_add_u32 s35, s32, 262144
  s_add_u32 s35, s35, s27
  buffer_load_dwordx4 v3, s[20:23], s35 offen lds
  s_add_u32 m0, s34, 36864
  s_add_u32 s35, s32, 327680
  s_add_u32 s35, s35, s27
  buffer_load_dwordx4 v3, s[20:23], s35 offen lds
  s_add_u32 m0, s34, 40960
  s_add_u32 s35, s32, 393216
  s_add_u32 s35, s35, s27
  buffer_load_dwordx4 v3, s[20:23], s35 offen lds
  v_mov_b32 v8, 143360
  v_mov_b32 v9, 0
  ds_write_b32 v8, v9
  s_waitcnt lgkmcnt(0)
  s_waitcnt vmcnt(0)
  s_barrier
  s_cmp_eq_u32 s26, s27
  s_cselect_b32 s4, 4096, 0
  s_add_u32 s26, s26, s4
  s_mov_b32 s24, s26
  s_add_u32 s26, s26, 4096
  s_cmp_eq_u32 s26, s27
  s_cselect_b32 s4, 4096, 0
  s_add_u32 s26, s26, s4
  s_mov_b32 s25, s26
  s_add_u32 s26, s26, 4096
  s_add_u32 m0, s34, 61440
  s_add_u32 s35, s32, 0
  s_add_u32 s35, s35, s24
  buffer_load_dwordx4 v3, s[20:23], s35 offen lds
  s_add_u32 m0, s34, 65536
  s_add_u32 s35, s32, 65536
  s_add_u32 s35, s35, s24
  buffer_load_dwordx4 v3, s[20:23], s35 offen lds
  s_add_u32 m0, s34, 69632
  s_add_u32 s35, s32, 131072
  s_add_u32 s35, s35, s24
  buffer_load_dwordx4 v3, s[20:23], s35 offen lds
  s_add_u32 m0, s34, 73728
  s_add_u32 s35, s32, 196608
  s_add_u32 s35, s35, s24
  buffer_load_dwordx4 v3, s[20:23], s35 offen lds
  s_add_u32 m0, s34, 77824
  s_add_u32 s35, s32, 262144
  s_add_u32 s35, s35, s24
  buffer_load_dwordx4 v3, s[20:23], s35 offen lds
  s_add_u32 m0, s34, 81920
  s_add_u32 s35, s32, 327680
  s_add_u32 s35, s35, s24
  buffer_load_dwordx4 v3, s[20:23], s35 offen lds
  s_add_u32 m0, s34, 86016
  s_add_u32 s35, s32, 393216
  s_add_u32 s35, s35, s24
  buffer_load_dwordx4 v3, s[20:23], s35 offen lds
  s_add_u32 m0, s34, 106496
  s_add_u32 s35, s32, 0
  s_add_u32 s35, s35, s25
  buffer_load_dwordx4 v3, s[20:23], s35 offen lds
  s_add_u32 m0, s34, 110592
  s_add_u32 s35, s32, 65536
  s_add_u32 s35, s35, s25
  buffer_load_dwordx4 v3, s[20:23], s35 offen lds
  s_add_u32 m0, s34, 114688
  s_add_u32 s35, s32, 131072
  s_add_u32 s35, s35, s25
  buffer_load_dwordx4 v3, s[20:23], s35 offen lds
  s_add_u32 m0, s34, 118784
  s_add_u32 s35, s32, 196608
  s_add_u32 s35, s35, s25
  buffer_load_dwordx4 v3, s[20:23], s35 offen lds
  s_add_u32 m0, s34, 122880
  s_add_u32 s35, s32, 262144
  s_add_u32 s35, s35, s25
  buffer_load_dwordx4 v3, s[20:23], s35 offen lds
  s_add_u32 m0, s34, 126976
  s_add_u32 s35, s32, 327680
  s_add_u32 s35, s35, s25
  buffer_load_dwordx4 v3, s[20:23], s35 offen lds
  s_add_u32 m0, s34, 131072
  s_add_u32 s35, s32, 393216
  s_add_u32 s35, s35, s25
  buffer_load_dwordx4 v3, s[20:23], s35 offen lds
  s_mov_b32 s16, s46
  s_mov_b32 s17, s47
  s_mov_b32 s18, 0x1c00
  s_mov_b32 s19, 0x20000
  v_min_u32 v6, 55, v2
  s_mul_i32 s5, s30, 56
  v_add_u32 v6, s5, v6
  s_mul_i32 s5, s90, 224
  v_add_u32 v7, s5, v6
  v_lshlrev_b32 v5, 1, v7
  v_lshlrev_b32 v7, 2, v7
  s_mov_b32 s4, 52428800
  buffer_load_dword v48, v7, s[20:23], s4 offen sc1
  s_add_u32 s4, s4, 14336
  buffer_load_dword v49, v7, s[20:23], s4 offen sc1
  s_add_u32 s4, s4, 14336
  buffer_load_dword v50, v7, s[20:23], s4 offen sc1
  s_add_u32 s4, s4, 14336
  buffer_load_dword v51, v7, s[20:23], s4 offen sc1
  s_add_u32 s4, s4, 14336
  buffer_load_dword v52, v7, s[20:23], s4 offen sc1
  s_add_u32 s4, s4, 14336
  buffer_load_dword v53, v7, s[20:23], s4 offen sc1
  s_add_u32 s4, s4, 14336
  buffer_load_dword v54, v7, s[20:23], s4 offen sc1
  s_add_u32 s4, s4, 14336
  buffer_load_dword v55, v7, s[20:23], s4 offen sc1
  s_add_u32 s4, s4, 14336
  buffer_load_dword v56, v7, s[20:23], s4 offen sc1
  s_add_u32 s4, s4, 14336
  buffer_load_dword v57, v7, s[20:23], s4 offen sc1
  s_add_u32 s4, s4, 14336
  buffer_load_dword v58, v7, s[20:23], s4 offen sc1
  s_add_u32 s4, s4, 14336
  buffer_load_dword v59, v7, s[20:23], s4 offen sc1
  s_add_u32 s4, s4, 14336
  buffer_load_dword v60, v7, s[20:23], s4 offen sc1
  s_add_u32 s4, s4, 14336
  buffer_load_dword v61, v7, s[20:23], s4 offen sc1
  s_add_u32 s4, s4, 14336
  buffer_load_dword v62, v7, s[20:23], s4 offen sc1
  s_add_u32 s4, s4, 14336
  buffer_load_dword v63, v7, s[20:23], s4 offen sc1
  s_add_u32 s4, s4, 14336
  buffer_load_dword v64, v7, s[20:23], s4 offen sc1
  s_add_u32 s4, s4, 14336
  buffer_load_dword v65, v7, s[20:23], s4 offen sc1
  s_add_u32 s4, s4, 14336
  buffer_load_dword v66, v7, s[20:23], s4 offen sc1
  s_add_u32 s4, s4, 14336
  buffer_load_dword v67, v7, s[20:23], s4 offen sc1
  s_add_u32 s4, s4, 14336
  buffer_load_dword v68, v7, s[20:23], s4 offen sc1
  s_add_u32 s4, s4, 14336
  buffer_load_dword v69, v7, s[20:23], s4 offen sc1
  s_add_u32 s4, s4, 14336
  buffer_load_dword v70, v7, s[20:23], s4 offen sc1
  s_add_u32 s4, s4, 14336
  buffer_load_dword v71, v7, s[20:23], s4 offen sc1
  s_add_u32 s4, s4, 14336
  buffer_load_dword v72, v7, s[20:23], s4 offen sc1
  s_add_u32 s4, s4, 14336
  buffer_load_dword v73, v7, s[20:23], s4 offen sc1
  s_add_u32 s4, s4, 14336
  buffer_load_dword v74, v7, s[20:23], s4 offen sc1
  s_add_u32 s4, s4, 14336
  buffer_load_dword v75, v7, s[20:23], s4 offen sc1
  s_add_u32 s4, s4, 14336
  buffer_load_dword v76, v7, s[20:23], s4 offen sc1
  s_add_u32 s4, s4, 14336
  buffer_load_dword v77, v7, s[20:23], s4 offen sc1
  s_add_u32 s4, s4, 14336
  buffer_load_dword v78, v7, s[20:23], s4 offen sc1
  s_add_u32 s4, s4, 14336
  buffer_load_dword v79, v7, s[20:23], s4 offen sc1
  s_add_u32 s4, s4, 14336
  buffer_load_ushort v40, v5, s[16:19], 0 offen
  s_getpc_b64 s[6:7]
CREF_13:
  s_sub_u32 s6, s6, CREF_13-K4_cons
  s_subb_u32 s7, s7, 0
  s_lshl_b32 s5, s30, 12
  v_lshlrev_b32 v42, 6, v2
  v_add_u32 v42, s5, v42
  v_min_u32 v42, CODE_END-K4_cons-4, v42
  global_load_dword v43, v42, s[6:7]
  s_lshl_b32 s4, s89, 13
  s_add_u32 s4, s4, 56885248
  s_lshl_b32 s62, s90, 9
  s_add_u32 s4, s4, s62
  v_lshlrev_b32 v4, 2, v2
  v_mov_b32 v9, 143360
  s_cmp_lg_u32 s30, 0
  s_cbranch_scc1 P1O_14
  s_mov_b32 s91, 200000
PTOP_18:
  buffer_load_dword v8, v4, s[20:23], s4 offen sc1
  s_waitcnt vmcnt(0)
  v_cmp_ne_u32 vcc, s88, v8
  s_cbranch_vccz POK_17
  s_sleep 4
  s_sub_u32 s91, s91, 1
  s_cmp_lg_u32 s91, 0
  s_cbranch_scc1 PTOP_18
POK_17:
  v_mov_b32 v8, 23044
  ds_write_b32 v9, v8
  s_branch P1G_15
P1O_14:
  s_mov_b32 s91, 1600000
  s_waitcnt vmcnt(0)
P1T_16:
  ds_read_b32 v8, v9
  s_sub_u32 s91, s91, 1
  s_waitcnt lgkmcnt(0)
  v_readfirstlane_b32 s62, v8
  s_cmp_eq_u32 s91, 0
  s_cbranch_scc1 P1G_15
  s_cmp_eq_u32 s62, 23044
  s_cbranch_scc1 P1G_15
  s_sleep 2
  s_branch P1T_16
P1G_15:
  s_add_u32 m0, s34, 45056
  s_add_u32 s35, s31, 0
  s_add_u32 s35, s35, s24
  buffer_load_dwordx4 v3, s[20:23], s35 offen lds
  s_add_u32 m0, s34, 49152
  s_add_u32 s35, s31, 65536
  s_add_u32 s35, s35, s24
  buffer_load_dwordx4 v3, s[20:23], s35 offen lds
  s_add_u32 m0, s34, 53248
  s_add_u32 s35, s31, 131072
  s_add_u32 s35, s35, s24
  buffer_load_dwordx4 v3, s[20:23], s35 offen lds
  s_add_u32 m0, s34, 57344
  s_add_u32 s35, s31, 196608
  s_add_u32 s35, s35, s24
  buffer_load_dwordx4 v3, s[20:23], s35 offen lds
  s_add_u32 m0, s34, 90112
  s_add_u32 s35, s31, 0
  s_add_u32 s35, s35, s25
  buffer_load_dwordx4 v3, s[20:23], s35 offen lds
  s_add_u32 m0, s34, 94208
  s_add_u32 s35, s31, 65536
  s_add_u32 s35, s35, s25
  buffer_load_dwordx4 v3, s[20:23], s35 offen lds
  s_add_u32 m0, s34, 98304
  s_add_u32 s35, s31, 131072
  s_add_u32 s35, s35, s25
  buffer_load_dwordx4 v3, s[20:23], s35 offen lds
  s_add_u32 m0, s34, 102400
  s_add_u32 s35, s31, 196608
  s_add_u32 s35, s35, s25
  buffer_load_dwordx4 v3, s[20:23], s35 offen lds
  v_and_b32 v4, 31, v2
  v_lshrrev_b32 v5, 5, v2
  v_lshlrev_b32 v4, 3, v4
  v_lshl_add_u32 v4, v5, 17, v4
  s_lshl_b32 s4, s89, 10
  s_lshl_b32 s5, s30, 8
  s_add_u32 s4, s4, s5
  s_add_u32 s4, s4, 53477376
  buffer_load_dwordx2 v[8:9], v4, s[20:23], s4 offen sc1
  s_add_u32 s4, s4, 16384
  buffer_load_dwordx2 v[10:11], v4, s[20:23], s4 offen sc1
  s_add_u32 s4, s4, 16384
  buffer_load_dwordx2 v[12:13], v4, s[20:23], s4 offen sc1
  s_add_u32 s4, s4, 16384
  buffer_load_dwordx2 v[14:15], v4, s[20:23], s4 offen sc1
  s_add_u32 s4, s4, 16384
  buffer_load_dwordx2 v[16:17], v4, s[20:23], s4 offen sc1
  s_add_u32 s4, s4, 16384
  buffer_load_dwordx2 v[18:19], v4, s[20:23], s4 offen sc1
  s_add_u32 s4, s4, 16384
  buffer_load_dwordx2 v[20:21], v4, s[20:23], s4 offen sc1
  s_add_u32 s4, s4, 16384
  buffer_load_dwordx2 v[22:23], v4, s[20:23], s4 offen sc1
  s_add_u32 s4, s4, 16384
  s_mov_b32 s33, s34
  s_waitcnt vmcnt(12)
  s_barrier
  s_call_b64 s[92:93], K4_issue
  s_waitcnt vmcnt(19)
  s_barrier
  s_call_b64 s[92:93], K4_issue
  s_waitcnt vmcnt(11)
  s_barrier
  s_call_b64 s[92:93], K4_issue
  v_add_f32 v8, v8, v10
  v_add_f32 v9, v9, v11
  v_add_f32 v8, v8, v12
  v_add_f32 v9, v9, v13
  v_add_f32 v8, v8, v14
  v_add_f32 v9, v9, v15
  v_add_f32 v8, v8, v16
  v_add_f32 v9, v9, v17
  v_add_f32 v8, v8, v18
  v_add_f32 v9, v9, v19
  v_add_f32 v8, v8, v20
  v_add_f32 v9, v9, v21
  v_add_f32 v8, v8, v22
  v_add_f32 v9, v9, v23
  v_add_f32 v24, v48, v49
  v_add_f32 v24, v24, v50
  v_add_f32 v24, v24, v51
  v_add_f32 v24, v24, v52
  v_add_f32 v24, v24, v53
  v_add_f32 v24, v24, v54
  v_add_f32 v24, v24, v55
  v_add_f32 v24, v24, v56
  v_add_f32 v24, v24, v57
  v_add_f32 v24, v24, v58
  v_add_f32 v24, v24, v59
  v_add_f32 v24, v24, v60
  v_add_f32 v24, v24, v61
  v_add_f32 v24, v24, v62
  v_add_f32 v24, v24, v63
  v_add_f32 v24, v24, v64
  v_add_f32 v24, v24, v65
  v_add_f32 v24, v24, v66
  v_add_f32 v24, v24, v67
  v_add_f32 v24, v24, v68
  v_add_f32 v24, v24, v69
  v_add_f32 v24, v24, v70
  v_add_f32 v24, v24, v71
  v_add_f32 v24, v24, v72
  v_add_f32 v24, v24, v73
  v_add_f32 v24, v24, v74
  v_add_f32 v24, v24, v75
  v_add_f32 v24, v24, v76
  v_add_f32 v24, v24, v77
  v_add_f32 v24, v24, v78
  v_add_f32 v24, v24, v79
  v_mov_b32 v10, v8
  v_mov_b32 v11, v9
  s_nop 1
  v_permlane32_swap_b32 v8, v10
  v_permlane32_swap_b32 v9, v11
  v_add_f32 v8, v8, v10
  v_add_f32 v9, v9, v11
  v_mul_f32 v8, 0x3a800000, v8
  v_mul_f32 v9, 0x3a800000, v9
  v_fma_f32 v9, -v8, v8, v9
  v_max_f32 v9, 0, v9
  v_add_f32 v10, 0x3727c5ac, v9
  v_rsq_f32 v10, v10
  s_nop 0
  v_mul_f32 v9, v9, v10
  v_mul_f32 v9, v9, v10
  v_add_f32 v9, 0x3727c5ac, v9
  v_rsq_f32 v9, v9
  s_nop 0
  v_mul_f32 v9, v9, v10
  v_mul_f32 v9, 0xbeeff558, v9
  v_mul_f32 v8, v8, v9
  v_sub_f32 v8, 0, v8
  v_and_b32 v4, 31, v2
  v_lshlrev_b32 v4, 2, v4
  s_lshl_b32 s5, s30, 7
  s_add_u32 s5, s5, 147456
  v_add_u32 v4, s5, v4
  ds_write_b32 v4, v9
  ds_write_b32 v4, v8 offset:512
  v_lshlrev_b32 v40, 16, v40
  v_lshlrev_b32 v6, 2, v6
  v_add_u32 v6, 148480, v6
  v_mul_f32 v40, 0xbeeff558, v40
  ds_write_b32 v6, v40
  ds_write_b32 v6, v24 offset:1024
  s_waitcnt lgkmcnt(0)
  s_mov_b32 s29, 10
K4_lloop:
  s_waitcnt vmcnt(11)
  s_barrier
  s_call_b64 s[92:93], K4_issue
  s_sub_u32 s29, s29, 1
  s_cmp_lg_u32 s29, 0
  s_cbranch_scc1 K4_lloop
  s_lshr_b32 s8, s34, 1
  s_add_u32 s8, s8, 55971328
  v_lshlrev_b32 v46, 3, v2
  buffer_load_dwordx2 v[44:45], v46, s[20:23], s8 offen sc1
  s_waitcnt vmcnt(12)
  s_barrier
  s_waitcnt vmcnt(0)
  s_barrier
  s_mov_b32 s91, 200000
  v_cmp_ne_u32 vcc, s88, v44
  v_cmp_ne_u32 s[62:63], s88, v45
  s_nop 0
  s_or_b64 vcc, vcc, s[62:63]
  s_cbranch_vccz POK_19
PTOP_20:
  buffer_load_dwordx2 v[44:45], v46, s[20:23], s8 offen sc1
  s_waitcnt vmcnt(0)
  v_cmp_ne_u32 vcc, s88, v44
  v_cmp_ne_u32 s[62:63], s88, v45
  s_nop 0
  s_or_b64 vcc, vcc, s[62:63]
  s_cbranch_vccz POK_19
  s_sleep 4
  s_sub_u32 s91, s91, 1
  s_cmp_lg_u32 s91, 0
  s_cbranch_scc1 PTOP_20
POK_19:
  s_barrier
  s_branch K5_load
K4_issue:
  s_cmp_eq_u32 s26, s27
  s_cselect_b32 s4, 4096, 0
  s_add_u32 s26, s26, s4
  s_add_u32 s24, s31, s26
  s_add_u32 s25, s32, s26
  s_add_u32 m0, s33, 0
  s_add_u32 s35, s24, 0
  buffer_load_dwordx4 v3, s[20:23], s35 offen lds
  s_add_u32 m0, s33, 4096
  s_add_u32 s35, s24, 65536
  buffer_load_dwordx4 v3, s[20:23], s35 offen lds
  s_add_u32 m0, s33, 8192
  s_add_u32 s35, s24, 131072
  buffer_load_dwordx4 v3, s[20:23], s35 offen lds
  s_add_u32 m0, s33, 12288
  s_add_u32 s35, s24, 196608
  buffer_load_dwordx4 v3, s[20:23], s35 offen lds
  s_add_u32 m0, s33, 16384
  s_add_u32 s35, s25, 0
  buffer_load_dwordx4 v3, s[20:23], s35 offen lds
  s_add_u32 m0, s33, 20480
  s_add_u32 s35, s25, 65536
  buffer_load_dwordx4 v3, s[20:23], s35 offen lds
  s_add_u32 m0, s33, 24576
  s_add_u32 s35, s25, 131072
  buffer_load_dwordx4 v3, s[20:23], s35 offen lds
  s_add_u32 m0, s33, 28672
  s_add_u32 s35, s25, 196608
  buffer_load_dwordx4 v3, s[20:23], s35 offen lds
  s_add_u32 m0, s33, 32768
  s_add_u32 s35, s25, 262144
  buffer_load_dwordx4 v3, s[20:23], s35 offen lds
  s_add_u32 m0, s33, 36864
  s_add_u32 s35, s25, 327680
  buffer_load_dwordx4 v3, s[20:23], s35 offen lds
  s_add_u32 m0, s33, 40960
  s_add_u32 s35, s25, 393216
  buffer_load_dwordx4 v3, s[20:23], s35 offen lds
  s_add_u32 s26, s26, 4096
  s_add_u32 s33, s33, 45056
  s_cmp_ge_u32 s33, 135168
  s_cselect_b32 s33, s34, s33
  s_setpc_b64 s[92:93]
K5_load:
  s_sub_u32 s30, s3, 4
  s_lshl_b32 s34, s30, 10
  s_and_b32 s28, s90, 1
  s_mul_i32 s26, s28, 90112
  s_add_u32 s26, s26, s34
  s_mul_i32 s31, s89, 917504
  s_add_u32 s31, s31, 20971520
  s_lshr_b32 s27, s90, 1
  s_mul_i32 s32, s27, 917504
  s_add_u32 s32, s32, 45088768
  s_mul_i32 s26, s90, 14336
  s_add_u32 s26, s26, s34
  s_add_u32 s25, s32, s26
  s_add_u32 m0, s34, 16384
  s_add_u32 s35, s25, 0
  buffer_load_dwordx4 v3, s[20:23], s35 offen lds
  s_add_u32 m0, s34, 20480
  s_add_u32 s35, s25, 229376
  buffer_load_dwordx4 v3, s[20:23], s35 offen lds
  s_add_u32 m0, s34, 24576
  s_add_u32 s35, s25, 458752
  buffer_load_dwordx4 v3, s[20:23], s35 offen lds
  s_add_u32 m0, s34, 28672
  s_add_u32 s35, s25, 688128
  buffer_load_dwordx4 v3, s[20:23], s35 offen lds
  s_add_u32 m0, s34, 49152
  s_add_u32 s35, s25, 4096
  buffer_load_dwordx4 v3, s[20:23], s35 offen lds
  s_add_u32 m0, s34, 53248
  s_add_u32 s35, s25, 233472
  buffer_load_dwordx4 v3, s[20:23], s35 offen lds
  s_add_u32 m0, s34, 57344
  s_add_u32 s35, s25, 462848
  buffer_load_dwordx4 v3, s[20:23], s35 offen lds
  s_add_u32 m0, s34, 61440
  s_add_u32 s35, s25, 692224
  buffer_load_dwordx4 v3, s[20:23], s35 offen lds
  s_add_u32 m0, s34, 81920
  s_add_u32 s35, s25, 8192
  buffer_load_dwordx4 v3, s[20:23], s35 offen lds
  s_add_u32 m0, s34, 86016
  s_add_u32 s35, s25, 237568
  buffer_load_dwordx4 v3, s[20:23], s35 offen lds
  s_add_u32 m0, s34, 90112
  s_add_u32 s35, s25, 466944
  buffer_load_dwordx4 v3, s[20:23], s35 offen lds
  s_add_u32 m0, s34, 94208
  s_add_u32 s35, s25, 696320
  buffer_load_dwordx4 v3, s[20:23], s35 offen lds
  s_and_b32 s10, s90, 14
  s_mul_i32 s10, s10, 14336
  s_mul_i32 s11, s28, 75776
  s_add_u32 s11, s11, s34
  s_sub_u32 s11, s11, 2048
  s_mov_b32 s26, s32
  s_call_b64 s[92:93], K5_kpos
  s_add_u32 s4, s25, 0
  s_mul_i32 s5, s90, 14336
  s_add_u32 s5, s5, s34
  s_add_u32 s5, s5, s32
  s_add_u32 s5, s5, 12288
  s_cmp_lt_u32 s30, 2
  s_cselect_b32 s27, s5, s4
  s_add_u32 m0, s34, 114688
  s_add_u32 s35, s27, 0
  buffer_load_dwordx4 v3, s[20:23], s35 offen lds
  s_add_u32 m0, s34, 118784
  s_add_u32 s35, s27, 229376
  buffer_load_dwordx4 v3, s[20:23], s35 offen lds
  s_add_u32 m0, s34, 122880
  s_add_u32 s35, s27, 458752
  buffer_load_dwordx4 v3, s[20:23], s35 offen lds
  s_add_u32 m0, s34, 126976
  s_add_u32 s35, s27, 688128
  buffer_load_dwordx4 v3, s[20:23], s35 offen lds
  s_getpc_b64 s[6:7]
CREF_21:
  s_sub_u32 s6, s6, CREF_21-K5_cons
  s_subb_u32 s7, s7, 0
  s_lshl_b32 s5, s30, 12
  v_lshlrev_b32 v42, 6, v2
  v_add_u32 v42, s5, v42
  v_min_u32 v42, CODE_END-K5_cons-4, v42
  global_load_dword v43, v42, s[6:7]
  s_lshl_b32 s8, s89, 13
  s_add_u32 s8, s8, 57016320
  s_lshl_b32 s62, s90, 9
  s_add_u32 s8, s8, s62
  v_lshlrev_b32 v4, 2, v2
  s_waitcnt vmcnt(0)
  s_barrier
  s_barrier
  s_barrier
  v_mov_b32 v9, 143360
  s_cmp_lg_u32 s30, 0
  s_cbranch_scc1 P1O_22
  s_mov_b32 s91, 200000
PTOP_26:
  buffer_load_dword v8, v4, s[20:23], s8 offen sc1
  s_waitcnt vmcnt(0)
  v_cmp_ne_u32 vcc, s88, v8
  s_cbranch_vccz POK_25
  s_sleep 4
  s_sub_u32 s91, s91, 1
  s_cmp_lg_u32 s91, 0
  s_cbranch_scc1 PTOP_26
POK_25:
  v_mov_b32 v8, 23045
  ds_write_b32 v9, v8
  s_branch P1G_23
P1O_22:
  s_mov_b32 s91, 1600000
  s_waitcnt vmcnt(0)
P1T_24:
  ds_read_b32 v8, v9
  s_sub_u32 s91, s91, 1
  s_waitcnt lgkmcnt(0)
  v_readfirstlane_b32 s62, v8
  s_cmp_eq_u32 s91, 0
  s_cbranch_scc1 P1G_23
  s_cmp_eq_u32 s62, 23045
  s_cbranch_scc1 P1G_23
  s_sleep 2
  s_branch P1T_24
P1G_23:
  s_cmp_lt_u32 s30, 2
  s_cbranch_scc1 K5_noa3
  s_add_u32 m0, s34, 98304
  s_add_u32 s35, s24, 0
  buffer_load_dwordx4 v3, s[20:23], s35 offen lds
  s_add_u32 m0, s34, 102400
  s_add_u32 s35, s24, 229376
  buffer_load_dwordx4 v3, s[20:23], s35 offen lds
  s_add_u32 m0, s34, 106496
  s_add_u32 s35, s24, 458752
  buffer_load_dwordx4 v3, s[20:23], s35 offen lds
  s_add_u32 m0, s34, 110592
  s_add_u32 s35, s24, 688128
  buffer_load_dwordx4 v3, s[20:23], s35 offen lds
K5_noa3:
  s_add_u32 s11, s11, 4096
  s_call_b64 s[92:93], K5_kpos
  s_mov_b32 s33, s34
  s_call_b64 s[92:93], K5_issF
  s_call_b64 s[92:93], K5_issF
  s_mov_b32 s29, 16
K5L_27:
  s_waitcnt vmcnt(16)
  s_barrier
  s_call_b64 s[92:93], K5_issF
  s_sub_u32 s29, s29, 1
  s_cmp_lg_u32 s29, 0
  s_cbranch_scc1 K5L_27
  s_add_u32 s11, s34, 151552
  s_mul_i32 s26, s28, 458752
  s_add_u32 s26, s26, s32
  s_call_b64 s[92:93], K5_kpos
  s_waitcnt vmcnt(16)
  s_barrier
  s_call_b64 s[92:93], K5_issH
  s_waitcnt vmcnt(14)
  s_barrier
  s_call_b64 s[92:93], K5_issH
  s_mov_b32 s29, 8
K5L_28:
  s_waitcnt vmcnt(12)
  s_barrier
  s_call_b64 s[92:93], K5_issH
  s_sub_u32 s29, s29, 1
  s_cmp_lg_u32 s29, 0
  s_cbranch_scc1 K5L_28
  s_lshl_b32 s8, s89, 4
  s_add_u32 s8, s8, s90
  s_xor_b32 s8, s8, 1
  s_lshl_b32 s9, s8, 15
  s_lshl_b32 s4, s30, 13
  s_add_u32 s9, s9, s4
  s_add_u32 s9, s9, 67108864
  s_lshl_b32 s8, s8, 7
  s_add_u32 s8, s8, 56098816
  v_and_b32 v4, 3, v2
  v_lshlrev_b32 v4, 2, v4
  s_mul_i32 s7, s30, 7168
  s_waitcnt vmcnt(12)
  s_barrier
  buffer_load_dword v8, v4, s[20:23], s8 offen sc1
  s_call_b64 s[92:93], K5_issH
  s_waitcnt vmcnt(13)
  s_barrier
  s_call_b64 s[92:93], K5_issH
  s_waitcnt vmcnt(12)
  s_barrier
  s_mov_b32 s91, 200000
  v_cmp_ne_u32 vcc, s88, v8
  s_cbranch_vccz POK_29
PTOP_30:
  buffer_load_dword v8, v4, s[20:23], s8 offen sc1
  s_waitcnt vmcnt(0)
  v_cmp_ne_u32 vcc, s88, v8
  s_cbranch_vccz POK_29
  s_sleep 4
  s_sub_u32 s91, s91, 1
  s_cmp_lg_u32 s91, 0
  s_cbranch_scc1 PTOP_30
POK_29:
  s_add_u32 s4, s33, s7
  s_add_u32 m0, s4, 0
  s_add_u32 s35, s9, 0
  buffer_load_dwordx4 v3, s[20:23], s35 offen offset:0 lds
  buffer_load_dwordx4 v3, s[20:23], s35 offen offset:1024 lds
  buffer_load_dwordx4 v3, s[20:23], s35 offen offset:2048 lds
  buffer_load_dwordx4 v3, s[20:23], s35 offen offset:3072 lds
  s_add_u32 s4, s33, s7
  s_add_u32 m0, s4, 4096
  s_add_u32 s35, s9, 4096
  buffer_load_dwordx4 v3, s[20:23], s35 offen offset:0 lds
  buffer_load_dwordx4 v3, s[20:23], s35 offen offset:1024 lds
  buffer_load_dwordx4 v3, s[20:23], s35 offen offset:2048 lds
  buffer_load_dwordx4 v3, s[20:23], s35 offen offset:3072 lds
  s_waitcnt vmcnt(14)
  s_barrier
  s_waitcnt vmcnt(8)
  s_barrier
  s_waitcnt vmcnt(0)
  s_barrier
  s_endpgm
K5_issF:
  s_add_u32 m0, s33, 0
  s_add_u32 s35, s24, 0
  buffer_load_dwordx4 v3, s[20:23], s35 offen lds
  s_add_u32 m0, s33, 4096
  s_add_u32 s35, s24, 229376
  buffer_load_dwordx4 v3, s[20:23], s35 offen lds
  s_add_u32 m0, s33, 8192
  s_add_u32 s35, s24, 458752
  buffer_load_dwordx4 v3, s[20:23], s35 offen lds
  s_add_u32 m0, s33, 12288
  s_add_u32 s35, s24, 688128
  buffer_load_dwordx4 v3, s[20:23], s35 offen lds
  s_add_u32 m0, s33, 16384
  s_add_u32 s35, s25, 0
  buffer_load_dwordx4 v3, s[20:23], s35 offen lds
  s_add_u32 m0, s33, 20480
  s_add_u32 s35, s25, 229376
  buffer_load_dwordx4 v3, s[20:23], s35 offen lds
  s_add_u32 m0, s33, 24576
  s_add_u32 s35, s25, 458752
  buffer_load_dwordx4 v3, s[20:23], s35 offen lds
  s_add_u32 m0, s33, 28672
  s_add_u32 s35, s25, 688128
  buffer_load_dwordx4 v3, s[20:23], s35 offen lds
  s_add_u32 s33, s33, 32768
  s_cmp_ge_u32 s33, 131072
  s_cselect_b32 s33, s34, s33
  s_add_u32 s11, s11, 4096
  s_branch K5_kpos
K5_issH:
  s_add_u32 m0, s33, 0
  s_add_u32 s35, s24, 0
  buffer_load_dwordx4 v3, s[20:23], s35 offen lds
  s_add_u32 m0, s33, 4096
  s_add_u32 s35, s24, 229376
  buffer_load_dwordx4 v3, s[20:23], s35 offen lds
  s_add_u32 m0, s33, 8192
  s_add_u32 s35, s24, 458752
  buffer_load_dwordx4 v3, s[20:23], s35 offen lds
  s_add_u32 m0, s33, 12288
  s_add_u32 s35, s24, 688128
  buffer_load_dwordx4 v3, s[20:23], s35 offen lds
  s_add_u32 m0, s33, 16384
  s_add_u32 s35, s25, 0
  buffer_load_dwordx4 v3, s[20:23], s35 offen lds
  s_add_u32 m0, s33, 20480
  s_add_u32 s35, s25, 229376
  buffer_load_dwordx4 v3, s[20:23], s35 offen lds
  s_add_u32 s33, s33, 32768
  s_cmp_ge_u32 s33, 131072
  s_cselect_b32 s33, s34, s33
  s_add_u32 s11, s11, 4096
K5_kpos:
  s_cmp_ge_i32 s11, s10
  s_cselect_b32 s4, 28672, 0
  s_add_u32 s4, s4, s11
  s_add_u32 s24, s31, s4
  s_add_u32 s25, s26, s4
  s_setpc_b64 s[92:93]
ALL_end:
  s_endpgm
CODE_END:
.section .rodata,"a"
.p2align 6
.amdhsa_kernel sequential_preLN__mha_block__mixer_channel_mlp__prompt_kernel
  .amdhsa_next_free_vgpr 256
  .amdhsa_next_free_sgpr 102
  .amdhsa_accum_offset 256
  .amdhsa_group_segment_fixed_size 0
  .amdhsa_kernarg_size 88
  .amdhsa_user_sgpr_count 2
  .amdhsa_user_sgpr_kernarg_segment_ptr 1
  .amdhsa_system_sgpr_workgroup_id_x 1
.end_amdhsa_kernel
```
